```python
import torch

def _softmax(x, axis=-1):
    return torch.softmax(x, dim=axis)
def _gelu(x):
    return torch.nn.functional.gelu(x, approximate="tanh")
def _silu(x):
    return torch.nn.functional.silu(x)
def _sigmoid(x):
    return torch.sigmoid(x)
def _layernorm(x, axis=-1, eps=1e-5):
    m = x.mean(dim=axis, keepdim=True)
    v = x.var(dim=axis, keepdim=True, unbiased=False)
    return (x - m) / torch.sqrt(v + eps)
def _scatter_add(tgt, idx, src, axis=0):
    return tgt.clone().index_add_(axis, idx, src)
def _segment_sum(src, seg, n):
    out = torch.zeros((n,) + src.shape[1:], dtype=src.dtype)
    return out.index_add_(0, seg, src)
def _pad(x, pw):
    flat = tuple(v for pair in reversed(pw) for v in pair)
    return torch.nn.functional.pad(x, flat)

kernel_name = 'gated_mix__sliding_local_dilated__mha_block__prompt'

def setup_inputs():

    _w = (lambda a: (lambda t: t.to(torch.bfloat16) if t.is_floating_point() else t)(torch.as_tensor(a)))
    def _A_setup():
        B, S, D = 1, 2048, 448
        return {
            "x": _w((lambda *s: torch.randn(*s, dtype=torch.bfloat16) * 0.05)(B, S, D)),
            "wqkv": _w((lambda *s: torch.randn(*s, dtype=torch.bfloat16) * 1.6)(D, 3 * D)),
            "wo": _w((lambda *s: torch.randn(*s, dtype=torch.bfloat16) * 0.05)(D, D)),
        }
    _A_in = _A_setup()

    def _B_setup():
        B, S, D, H = 1, 2048, 448, 16
        return {
            "x": _w((lambda *s: torch.randn(*s, dtype=torch.bfloat16) * 0.05)(B, S, D)),
            "wqkv": _w((lambda *s: torch.randn(*s, dtype=torch.bfloat16) * 1.6)(D, 3 * D)),
            "wo": _w((lambda *s: torch.randn(*s, dtype=torch.bfloat16) * 0.1)(D, D)),
        }
    _B_in = _B_setup()

    return {
        "A_x": _A_in["x"],
        "A_wqkv": _A_in["wqkv"],
        "A_wo": _A_in["wo"],
        "B_x": _B_in["x"],
        "B_wqkv": _B_in["wqkv"],
        "B_wo": _B_in["wo"],
        "gate_w": _w((lambda *s: torch.randn(*s, dtype=torch.bfloat16) * 0.05)(448) * 16.0),
    }

def reference(A_x, A_wqkv, A_wo, B_x, B_wqkv, B_wo, gate_w):
    def _A_ref(x, wqkv, wo):
        B, S, D = x.shape
        H = 16; Dh = D // H
        W, dil = 8, 2
        qkv = (lambda x, *d: x.permute(*d))((x @ wqkv).reshape(B, S, 3, H, Dh), 2, 0, 3, 1, 4)
        q, k, v = qkv[0], qkv[1], qkv[2]
        scale = Dh ** -0.5
        pos = torch.arange(S)
        off = torch.arange(W) * dil
        idx = pos[:, None] - off[None, :]
        mask = idx >= 0
        idx_c = torch.where(mask, idx, 0).reshape(-1)
        kg = k[:, :, idx_c, :].reshape(B, H, S, W, Dh)
        vg = v[:, :, idx_c, :].reshape(B, H, S, W, Dh)
        logits = torch.einsum("bhsd,bhswd->bhsw", q, kg) * scale
        logits = torch.where(mask[None, None, :, :], logits, -1e9)
        attn = _softmax(logits, axis=-1)
        o = torch.einsum("bhsw,bhswd->bhsd", attn, vg)
        return (lambda x, *d: x.permute(*d))(o, 0, 2, 1, 3).reshape(B, S, D) @ wo

    def _B_ref(x, wqkv, wo):
        B, S, D = x.shape
        H = 16
        Dh = D // H
        qkv = (lambda x, *d: x.permute(*d))((x @ wqkv).reshape(B, S, 3, H, Dh), 2, 0, 3, 1, 4)
        q, k, v = qkv[0], qkv[1], qkv[2]
        scores = torch.einsum("bhqd,bhkd->bhqk", q, k) * (Dh ** -0.5)
        p = _softmax(scores, axis=-1)
        o = torch.einsum("bhqk,bhkd->bhqd", p, v)
        return (lambda x, *d: x.permute(*d))(o, 0, 2, 1, 3).reshape(B, S, D) @ wo

    x = A_x
    g = _sigmoid((x * gate_w).sum(-1, keepdims=True))
    a = _A_ref(x, A_wqkv, A_wo)
    b = _B_ref(x, B_wqkv, B_wo)
    return g * a + (1 - g) * b
```

```asm
; @launch kernel=qkv_kernel grid=(256,1,1) block=(512,1,1) lds=122880
; @launch kernel=attn_kernel grid=(256,1,1) block=(512,1,1) lds=151616
; @launch kernel=out_kernel grid=(224,1,1) block=(512,1,1) lds=163840
.amdgcn_target "amdgcn-amd-amdhsa--gfx950"
.text
.p2align 8
.globl qkv_kernel
.type qkv_kernel,@function
qkv_kernel:
    s_cmp_ge_u32 s2, 256
    s_cbranch_scc1 K1_END
    s_load_dwordx4 s[4:7], s[0:1], 0
    s_load_dwordx2 s[20:21], s[0:1], 16
    s_load_dwordx4 s[24:27], s[0:1], 32
    s_load_dwordx2 s[28:29], s[0:1], 48
    s_load_dwordx2 s[30:31], s[0:1], 72
    s_and_b32 s51, s2, 7
    s_lshr_b32 s52, s2, 3
    s_and_b32 s53, s51, 1
    s_lshl_b32 s53, s53, 3
    s_lshr_b32 s54, s52, 2
    s_add_u32 s44, s53, s54
    s_lshr_b32 s53, s51, 1
    s_lshl_b32 s53, s53, 2
    s_and_b32 s54, s52, 3
    s_add_u32 s45, s53, s54
    s_lshr_b32 s46, s45, 3
    s_and_b32 s47, s45, 7
    v_lshrrev_b32 v1, 6, v0
    v_and_b32 v2, 63, v0
    v_readfirstlane_b32 s59, v1
    s_and_b32 s48, s59, 3
    s_and_b32 s49, s48, 1
    s_lshr_b32 s50, s48, 1
    s_cmp_lt_u32 s59, 4
    s_cbranch_scc1 K1_COMPUTE
    s_sub_u32 s48, s59, 4
    v_lshrrev_b32 v11, 3, v2
    s_lshl_b32 s51, s44, 7
    s_lshl_b32 s52, s48, 3
    s_add_u32 s51, s51, s52
    v_add_u32 v11, s51, v11
    s_movk_i32 s52, 896
    v_mul_lo_u32 v12, v11, s52
    v_lshrrev_b32 v11, 4, v2
    s_lshl_b32 s52, s48, 2
    v_add_u32 v11, s52, v11
    v_and_b32 v11, 7, v11
    v_and_b32 v13, 7, v2
    v_xor_b32 v11, v11, v13
    v_lshl_add_u32 v12, v11, 4, v12
    s_mul_i32 s52, s47, 112
    s_lshl_b32 s51, s48, 6
    s_add_u32 s51, s51, 0
    v_add_u32 v44, s51, v2
    s_movk_i32 s53, 3121
    v_mul_lo_u32 v45, v44, s53
    v_lshrrev_b32 v45, 16, v45
    v_mul_u32_u24 v46, 21, v45
    v_sub_u32 v46, v44, v46
    v_mul_u32_u24 v47, 37, v46
    v_lshrrev_b32 v47, 8, v47
    v_and_b32 v48, 0xfffffff0, v45
    v_and_b32 v49, 3, v45
    v_lshl_or_b32 v48, v49, 2, v48
    v_bfe_u32 v49, v45, 2, 2
    v_or_b32 v48, v48, v49
    s_movk_i32 s53, 2688
    v_mul_lo_u32 v48, v48, s53
    s_movk_i32 s53, 784
    v_mul_lo_u32 v47, v47, s53
    v_lshl_add_u32 v14, v46, 4, v48
    v_add3_u32 v14, v14, v47, s52
    s_lshl_b32 s51, s48, 6
    s_add_u32 s51, s51, 256
    v_add_u32 v44, s51, v2
    s_movk_i32 s53, 3121
    v_mul_lo_u32 v45, v44, s53
    v_lshrrev_b32 v45, 16, v45
    v_mul_u32_u24 v46, 21, v45
    v_sub_u32 v46, v44, v46
    v_mul_u32_u24 v47, 37, v46
    v_lshrrev_b32 v47, 8, v47
    v_and_b32 v48, 0xfffffff0, v45
    v_and_b32 v49, 3, v45
    v_lshl_or_b32 v48, v49, 2, v48
    v_bfe_u32 v49, v45, 2, 2
    v_or_b32 v48, v48, v49
    s_movk_i32 s53, 2688
    v_mul_lo_u32 v48, v48, s53
    s_movk_i32 s53, 784
    v_mul_lo_u32 v47, v47, s53
    v_lshl_add_u32 v15, v46, 4, v48
    v_add3_u32 v15, v15, v47, s52
    s_lshl_b32 s51, s48, 6
    s_add_u32 s51, s51, 512
    v_add_u32 v44, s51, v2
    s_movk_i32 s53, 3121
    v_mul_lo_u32 v45, v44, s53
    v_lshrrev_b32 v45, 16, v45
    v_mul_u32_u24 v46, 21, v45
    v_sub_u32 v46, v44, v46
    v_mul_u32_u24 v47, 37, v46
    v_lshrrev_b32 v47, 8, v47
    v_and_b32 v48, 0xfffffff0, v45
    v_and_b32 v49, 3, v45
    v_lshl_or_b32 v48, v49, 2, v48
    v_bfe_u32 v49, v45, 2, 2
    v_or_b32 v48, v48, v49
    s_movk_i32 s53, 2688
    v_mul_lo_u32 v48, v48, s53
    s_movk_i32 s53, 784
    v_mul_lo_u32 v47, v47, s53
    v_lshl_add_u32 v16, v46, 4, v48
    v_add3_u32 v16, v16, v47, s52
    s_lshl_b32 s51, s48, 6
    s_add_u32 s51, s51, 768
    v_add_u32 v44, s51, v2
    s_movk_i32 s53, 3121
    v_mul_lo_u32 v45, v44, s53
    v_lshrrev_b32 v45, 16, v45
    v_mul_u32_u24 v46, 21, v45
    v_sub_u32 v46, v44, v46
    v_mul_u32_u24 v47, 37, v46
    v_lshrrev_b32 v47, 8, v47
    v_and_b32 v48, 0xfffffff0, v45
    v_and_b32 v49, 3, v45
    v_lshl_or_b32 v48, v49, 2, v48
    v_bfe_u32 v49, v45, 2, 2
    v_or_b32 v48, v48, v49
    s_movk_i32 s53, 2688
    v_mul_lo_u32 v48, v48, s53
    s_movk_i32 s53, 784
    v_mul_lo_u32 v47, v47, s53
    v_lshl_add_u32 v17, v46, 4, v48
    v_add3_u32 v17, v17, v47, s52
    s_lshl_b32 s51, s48, 6
    s_add_u32 s51, s51, 1024
    v_add_u32 v44, s51, v2
    s_movk_i32 s53, 3121
    v_mul_lo_u32 v45, v44, s53
    v_lshrrev_b32 v45, 16, v45
    v_mul_u32_u24 v46, 21, v45
    v_sub_u32 v46, v44, v46
    v_mul_u32_u24 v47, 37, v46
    v_lshrrev_b32 v47, 8, v47
    v_and_b32 v48, 0xfffffff0, v45
    v_and_b32 v49, 3, v45
    v_lshl_or_b32 v48, v49, 2, v48
    v_bfe_u32 v49, v45, 2, 2
    v_or_b32 v48, v48, v49
    s_movk_i32 s53, 2688
    v_mul_lo_u32 v48, v48, s53
    s_movk_i32 s53, 784
    v_mul_lo_u32 v47, v47, s53
    v_lshl_add_u32 v18, v46, 4, v48
    v_add3_u32 v18, v18, v47, s52
    s_lshl_b32 s51, s48, 6
    s_add_u32 s51, s51, 1280
    v_add_u32 v44, s51, v2
    s_movk_i32 s53, 3121
    v_mul_lo_u32 v45, v44, s53
    v_lshrrev_b32 v45, 16, v45
    v_mul_u32_u24 v46, 21, v45
    v_sub_u32 v46, v44, v46
    v_mul_u32_u24 v47, 37, v46
    v_lshrrev_b32 v47, 8, v47
    v_and_b32 v48, 0xfffffff0, v45
    v_and_b32 v49, 3, v45
    v_lshl_or_b32 v48, v49, 2, v48
    v_bfe_u32 v49, v45, 2, 2
    v_or_b32 v48, v48, v49
    s_movk_i32 s53, 2688
    v_mul_lo_u32 v48, v48, s53
    s_movk_i32 s53, 784
    v_mul_lo_u32 v47, v47, s53
    v_lshl_add_u32 v19, v46, 4, v48
    v_add3_u32 v19, v19, v47, s52
    s_lshl_b32 s55, s48, 10
    s_waitcnt lgkmcnt(0)
    s_mov_b32 s8, s4
    s_and_b32 s9, s5, 0xffff
    s_mov_b32 s10, 1835008
    s_mov_b32 s11, 0x20000
    s_cmp_eq_u32 s46, 0
    s_cselect_b32 s12, s6, s24
    s_cselect_b32 s13, s7, s25
    s_and_b32 s13, s13, 0xffff
    s_mov_b32 s14, 1204224
    s_mov_b32 s15, 0x20000
    s_add_u32 s51, s55, 0
    s_mov_b32 m0, s51
    s_mov_b32 s52, 0
    buffer_load_dwordx4 v12, s[8:11], s52 offen lds
    s_add_u32 s51, s55, 4096
    s_mov_b32 m0, s51
    s_mov_b32 s52, 28672
    buffer_load_dwordx4 v12, s[8:11], s52 offen lds
    s_add_u32 s51, s55, 8192
    s_mov_b32 m0, s51
    s_mov_b32 s52, 57344
    buffer_load_dwordx4 v12, s[8:11], s52 offen lds
    s_add_u32 s51, s55, 12288
    s_mov_b32 m0, s51
    s_mov_b32 s52, 86016
    buffer_load_dwordx4 v12, s[8:11], s52 offen lds
    s_add_u32 s51, s55, 16384
    s_mov_b32 m0, s51
    s_mov_b32 s52, 0
    buffer_load_dwordx4 v14, s[12:15], s52 offen lds
    s_add_u32 s51, s55, 20480
    s_mov_b32 m0, s51
    s_mov_b32 s52, 0
    buffer_load_dwordx4 v15, s[12:15], s52 offen lds
    s_add_u32 s51, s55, 24576
    s_mov_b32 m0, s51
    s_mov_b32 s52, 0
    buffer_load_dwordx4 v16, s[12:15], s52 offen lds
    s_add_u32 s51, s55, 28672
    s_mov_b32 m0, s51
    s_mov_b32 s52, 0
    buffer_load_dwordx4 v17, s[12:15], s52 offen lds
    s_add_u32 s51, s55, 32768
    s_mov_b32 m0, s51
    s_mov_b32 s52, 0
    buffer_load_dwordx4 v18, s[12:15], s52 offen lds
    s_add_u32 s51, s55, 36864
    s_mov_b32 m0, s51
    s_mov_b32 s52, 0
    buffer_load_dwordx4 v19, s[12:15], s52 offen lds
    s_lshr_b32 s51, s2, 3
    s_and_b32 s52, s2, 1
    s_mul_i32 s52, s52, 917504
    s_mul_i32 s53, s51, 28672
    s_add_u32 s52, s52, s53
    v_and_b32 v7, 255, v0
    v_lshlrev_b32 v3, 7, v7
    v_mov_b32 v8, 0x40000000
    v_cmp_gt_u32 vcc, 224, v7
    s_nop 1
    v_cndmask_b32 v3, v8, v3, vcc
    buffer_load_dword v20, v3, s[8:11], s52 offen
    s_mul_i32 s53, s51, 210
    v_add_u32 v3, s53, v7
    s_mov_b32 s53, 52429
    v_mul_lo_u32 v4, v3, s53
    v_lshrrev_b32 v4, 18, v4
    v_mul_u32_u24 v5, 5, v4
    v_sub_u32 v5, v3, v5
    v_mul_u32_u24 v6, 896, v4
    v_lshlrev_b32 v5, 7, v5
    v_min_u32 v5, 444, v5
    v_add_u32 v6, v6, v5
    v_cmp_gt_u32 vcc, 210, v7
    s_nop 1
    v_cndmask_b32 v6, v8, v6, vcc
    s_and_b32 s53, s47, 4
    s_mul_i32 s53, s53, 112
    buffer_load_dword v21, v6, s[12:15], s53 offen
    s_add_u32 s51, s55, 40960
    s_mov_b32 m0, s51
    s_mov_b32 s52, 128
    buffer_load_dwordx4 v12, s[8:11], s52 offen lds
    s_add_u32 s51, s55, 45056
    s_mov_b32 m0, s51
    s_mov_b32 s52, 28800
    buffer_load_dwordx4 v12, s[8:11], s52 offen lds
    s_add_u32 s51, s55, 49152
    s_mov_b32 m0, s51
    s_mov_b32 s52, 57472
    buffer_load_dwordx4 v12, s[8:11], s52 offen lds
    s_add_u32 s51, s55, 53248
    s_mov_b32 m0, s51
    s_mov_b32 s52, 86144
    buffer_load_dwordx4 v12, s[8:11], s52 offen lds
    s_add_u32 s51, s55, 57344
    s_mov_b32 m0, s51
    s_mov_b32 s52, 172032
    buffer_load_dwordx4 v14, s[12:15], s52 offen lds
    s_add_u32 s51, s55, 61440
    s_mov_b32 m0, s51
    s_mov_b32 s52, 172032
    buffer_load_dwordx4 v15, s[12:15], s52 offen lds
    s_add_u32 s51, s55, 65536
    s_mov_b32 m0, s51
    s_mov_b32 s52, 172032
    buffer_load_dwordx4 v16, s[12:15], s52 offen lds
    s_add_u32 s51, s55, 69632
    s_mov_b32 m0, s51
    s_mov_b32 s52, 172032
    buffer_load_dwordx4 v17, s[12:15], s52 offen lds
    s_add_u32 s51, s55, 73728
    s_mov_b32 m0, s51
    s_mov_b32 s52, 172032
    buffer_load_dwordx4 v18, s[12:15], s52 offen lds
    s_add_u32 s51, s55, 77824
    s_mov_b32 m0, s51
    s_mov_b32 s52, 172032
    buffer_load_dwordx4 v19, s[12:15], s52 offen lds
    s_waitcnt vmcnt(12)
    s_barrier
    s_add_u32 s51, s55, 81920
    s_mov_b32 m0, s51
    s_mov_b32 s52, 256
    buffer_load_dwordx4 v12, s[8:11], s52 offen lds
    s_add_u32 s51, s55, 86016
    s_mov_b32 m0, s51
    s_mov_b32 s52, 28928
    buffer_load_dwordx4 v12, s[8:11], s52 offen lds
    s_add_u32 s51, s55, 90112
    s_mov_b32 m0, s51
    s_mov_b32 s52, 57600
    buffer_load_dwordx4 v12, s[8:11], s52 offen lds
    s_add_u32 s51, s55, 94208
    s_mov_b32 m0, s51
    s_mov_b32 s52, 86272
    buffer_load_dwordx4 v12, s[8:11], s52 offen lds
    s_add_u32 s51, s55, 98304
    s_mov_b32 m0, s51
    s_mov_b32 s52, 344064
    buffer_load_dwordx4 v14, s[12:15], s52 offen lds
    s_add_u32 s51, s55, 102400
    s_mov_b32 m0, s51
    s_mov_b32 s52, 344064
    buffer_load_dwordx4 v15, s[12:15], s52 offen lds
    s_add_u32 s51, s55, 106496
    s_mov_b32 m0, s51
    s_mov_b32 s52, 344064
    buffer_load_dwordx4 v16, s[12:15], s52 offen lds
    s_add_u32 s51, s55, 110592
    s_mov_b32 m0, s51
    s_mov_b32 s52, 344064
    buffer_load_dwordx4 v17, s[12:15], s52 offen lds
    s_add_u32 s51, s55, 114688
    s_mov_b32 m0, s51
    s_mov_b32 s52, 344064
    buffer_load_dwordx4 v18, s[12:15], s52 offen lds
    s_add_u32 s51, s55, 118784
    s_mov_b32 m0, s51
    s_mov_b32 s52, 344064
    buffer_load_dwordx4 v19, s[12:15], s52 offen lds
    s_waitcnt vmcnt(10)
    s_barrier
    s_add_u32 s51, s55, 0
    s_mov_b32 m0, s51
    s_mov_b32 s52, 384
    buffer_load_dwordx4 v12, s[8:11], s52 offen lds
    s_add_u32 s51, s55, 4096
    s_mov_b32 m0, s51
    s_mov_b32 s52, 29056
    buffer_load_dwordx4 v12, s[8:11], s52 offen lds
    s_add_u32 s51, s55, 8192
    s_mov_b32 m0, s51
    s_mov_b32 s52, 57728
    buffer_load_dwordx4 v12, s[8:11], s52 offen lds
    s_add_u32 s51, s55, 12288
    s_mov_b32 m0, s51
    s_mov_b32 s52, 86400
    buffer_load_dwordx4 v12, s[8:11], s52 offen lds
    s_add_u32 s51, s55, 16384
    s_mov_b32 m0, s51
    s_mov_b32 s52, 516096
    buffer_load_dwordx4 v14, s[12:15], s52 offen lds
    s_add_u32 s51, s55, 20480
    s_mov_b32 m0, s51
    s_mov_b32 s52, 516096
    buffer_load_dwordx4 v15, s[12:15], s52 offen lds
    s_add_u32 s51, s55, 24576
    s_mov_b32 m0, s51
    s_mov_b32 s52, 516096
    buffer_load_dwordx4 v16, s[12:15], s52 offen lds
    s_add_u32 s51, s55, 28672
    s_mov_b32 m0, s51
    s_mov_b32 s52, 516096
    buffer_load_dwordx4 v17, s[12:15], s52 offen lds
    s_add_u32 s51, s55, 32768
    s_mov_b32 m0, s51
    s_mov_b32 s52, 516096
    buffer_load_dwordx4 v18, s[12:15], s52 offen lds
    s_add_u32 s51, s55, 36864
    s_mov_b32 m0, s51
    s_mov_b32 s52, 516096
    buffer_load_dwordx4 v19, s[12:15], s52 offen lds
    s_waitcnt vmcnt(10)
    s_barrier
    s_add_u32 s51, s55, 40960
    s_mov_b32 m0, s51
    s_mov_b32 s52, 512
    buffer_load_dwordx4 v12, s[8:11], s52 offen lds
    s_add_u32 s51, s55, 45056
    s_mov_b32 m0, s51
    s_mov_b32 s52, 29184
    buffer_load_dwordx4 v12, s[8:11], s52 offen lds
    s_add_u32 s51, s55, 49152
    s_mov_b32 m0, s51
    s_mov_b32 s52, 57856
    buffer_load_dwordx4 v12, s[8:11], s52 offen lds
    s_add_u32 s51, s55, 53248
    s_mov_b32 m0, s51
    s_mov_b32 s52, 86528
    buffer_load_dwordx4 v12, s[8:11], s52 offen lds
    s_add_u32 s51, s55, 57344
    s_mov_b32 m0, s51
    s_mov_b32 s52, 688128
    buffer_load_dwordx4 v14, s[12:15], s52 offen lds
    s_add_u32 s51, s55, 61440
    s_mov_b32 m0, s51
    s_mov_b32 s52, 688128
    buffer_load_dwordx4 v15, s[12:15], s52 offen lds
    s_add_u32 s51, s55, 65536
    s_mov_b32 m0, s51
    s_mov_b32 s52, 688128
    buffer_load_dwordx4 v16, s[12:15], s52 offen lds
    s_add_u32 s51, s55, 69632
    s_mov_b32 m0, s51
    s_mov_b32 s52, 688128
    buffer_load_dwordx4 v17, s[12:15], s52 offen lds
    s_add_u32 s51, s55, 73728
    s_mov_b32 m0, s51
    s_mov_b32 s52, 688128
    buffer_load_dwordx4 v18, s[12:15], s52 offen lds
    s_add_u32 s51, s55, 77824
    s_mov_b32 m0, s51
    s_mov_b32 s52, 688128
    buffer_load_dwordx4 v19, s[12:15], s52 offen lds
    s_waitcnt vmcnt(10)
    s_barrier
    s_add_u32 s51, s55, 81920
    s_mov_b32 m0, s51
    s_mov_b32 s52, 640
    buffer_load_dwordx4 v12, s[8:11], s52 offen lds
    s_add_u32 s51, s55, 86016
    s_mov_b32 m0, s51
    s_mov_b32 s52, 29312
    buffer_load_dwordx4 v12, s[8:11], s52 offen lds
    s_add_u32 s51, s55, 90112
    s_mov_b32 m0, s51
    s_mov_b32 s52, 57984
    buffer_load_dwordx4 v12, s[8:11], s52 offen lds
    s_add_u32 s51, s55, 94208
    s_mov_b32 m0, s51
    s_mov_b32 s52, 86656
    buffer_load_dwordx4 v12, s[8:11], s52 offen lds
    s_add_u32 s51, s55, 98304
    s_mov_b32 m0, s51
    s_mov_b32 s52, 860160
    buffer_load_dwordx4 v14, s[12:15], s52 offen lds
    s_add_u32 s51, s55, 102400
    s_mov_b32 m0, s51
    s_mov_b32 s52, 860160
    buffer_load_dwordx4 v15, s[12:15], s52 offen lds
    s_add_u32 s51, s55, 106496
    s_mov_b32 m0, s51
    s_mov_b32 s52, 860160
    buffer_load_dwordx4 v16, s[12:15], s52 offen lds
    s_add_u32 s51, s55, 110592
    s_mov_b32 m0, s51
    s_mov_b32 s52, 860160
    buffer_load_dwordx4 v17, s[12:15], s52 offen lds
    s_add_u32 s51, s55, 114688
    s_mov_b32 m0, s51
    s_mov_b32 s52, 860160
    buffer_load_dwordx4 v18, s[12:15], s52 offen lds
    s_add_u32 s51, s55, 118784
    s_mov_b32 m0, s51
    s_mov_b32 s52, 860160
    buffer_load_dwordx4 v19, s[12:15], s52 offen lds
    s_waitcnt vmcnt(10)
    s_barrier
    s_add_u32 s51, s55, 0
    s_mov_b32 m0, s51
    s_mov_b32 s52, 768
    buffer_load_dwordx4 v12, s[8:11], s52 offen lds
    s_add_u32 s51, s55, 4096
    s_mov_b32 m0, s51
    s_mov_b32 s52, 29440
    buffer_load_dwordx4 v12, s[8:11], s52 offen lds
    s_add_u32 s51, s55, 8192
    s_mov_b32 m0, s51
    s_mov_b32 s52, 58112
    buffer_load_dwordx4 v12, s[8:11], s52 offen lds
    s_add_u32 s51, s55, 12288
    s_mov_b32 m0, s51
    s_mov_b32 s52, 86784
    buffer_load_dwordx4 v12, s[8:11], s52 offen lds
    s_add_u32 s51, s55, 16384
    s_mov_b32 m0, s51
    s_mov_b32 s52, 1032192
    buffer_load_dwordx4 v14, s[12:15], s52 offen lds
    s_add_u32 s51, s55, 20480
    s_mov_b32 m0, s51
    s_mov_b32 s52, 1032192
    buffer_load_dwordx4 v15, s[12:15], s52 offen lds
    s_add_u32 s51, s55, 24576
    s_mov_b32 m0, s51
    s_mov_b32 s52, 1032192
    buffer_load_dwordx4 v16, s[12:15], s52 offen lds
    s_add_u32 s51, s55, 28672
    s_mov_b32 m0, s51
    s_mov_b32 s52, 1032192
    buffer_load_dwordx4 v17, s[12:15], s52 offen lds
    s_add_u32 s51, s55, 32768
    s_mov_b32 m0, s51
    s_mov_b32 s52, 1032192
    buffer_load_dwordx4 v18, s[12:15], s52 offen lds
    s_add_u32 s51, s55, 36864
    s_mov_b32 m0, s51
    s_mov_b32 s52, 1032192
    buffer_load_dwordx4 v19, s[12:15], s52 offen lds
    s_waitcnt vmcnt(10)
    s_barrier
    s_waitcnt vmcnt(0)
    s_barrier
    s_endpgm
K1_COMPUTE:
    s_waitcnt lgkmcnt(0)
    s_mov_b32 s8, s4
    s_and_b32 s9, s5, 0xffff
    s_mov_b32 s10, 1835008
    s_mov_b32 s11, 0x20000
    s_mov_b32 s16, s30
    s_and_b32 s17, s31, 0xffff
    s_mov_b32 s18, 18874368
    s_mov_b32 s19, 0x20000
    s_mov_b32 s40, s28
    s_and_b32 s41, s29, 0xffff
    s_mov_b32 s42, 896
    s_mov_b32 s43, 0x20000
    v_and_b32 v3, 31, v2
    v_lshrrev_b32 v4, 5, v2
    s_lshl_b32 s51, s2, 3
    s_lshl_b32 s52, s48, 1
    s_add_u32 s51, s51, s52
    v_add_u32 v5, s51, v4
    s_movk_i32 s52, 896
    v_mul_lo_u32 v6, v5, s52
    v_lshlrev_b32 v7, 5, v3
    v_add_u32 v6, v6, v7
    v_mov_b32 v8, 0x40000000
    v_cmp_gt_u32 vcc, 28, v3
    s_nop 1
    v_cndmask_b32 v6, v8, v6, vcc
    v_cndmask_b32 v7, v8, v7, vcc
    buffer_load_dwordx4 v[20:23], v6, s[8:11], 0 offen
    buffer_load_dwordx4 v[24:27], v6, s[8:11], 0 offen offset:16
    buffer_load_dwordx4 v[28:31], v7, s[40:43], 0 offen
    buffer_load_dwordx4 v[32:35], v7, s[40:43], 0 offen offset:16
    s_lshl_b32 s51, s2, 2
    s_add_u32 s51, s51, s48
    s_and_b32 s52, s51, 63
    s_lshr_b32 s53, s51, 6
    s_lshr_b32 s54, s52, 5
    s_cmp_eq_u32 s54, 0
    s_cselect_b32 s32, s20, s26
    s_cselect_b32 s33, s21, s27
    s_and_b32 s33, s33, 0xffff
    s_mov_b32 s34, 401408
    s_mov_b32 s35, 0x20000
    s_lshr_b32 s55, s52, 1
    s_and_b32 s55, s55, 15
    s_and_b32 s56, s52, 1
    s_mul_i32 s55, s55, 28
    s_lshl_b32 s57, s56, 4
    s_add_u32 s55, s55, s57
    v_lshlrev_b32 v9, 2, v4
    v_add_u32 v9, s55, v9
    s_movk_i32 s52, 896
    v_mul_lo_u32 v9, v9, s52
    s_lshl_b32 s53, s53, 6
    v_lshlrev_b32 v10, 1, v3
    v_add3_u32 v9, v9, v10, s53
    v_add_u32 v10, 7168, v9
    v_and_b32 v11, s56, v4
    v_cmp_eq_u32 vcc, 0, v11
    s_nop 1
    v_cndmask_b32 v10, v8, v10, vcc
    s_cmp_ge_u32 s2, 224
    s_cselect_b32 s58, 0x40000000, 0
    buffer_load_ushort v36, v9, s[32:35], s58 offen offset:0
    buffer_load_ushort v37, v9, s[32:35], s58 offen offset:896
    buffer_load_ushort v38, v9, s[32:35], s58 offen offset:1792
    buffer_load_ushort v39, v9, s[32:35], s58 offen offset:2688
    buffer_load_ushort v40, v10, s[32:35], s58 offen offset:0
    buffer_load_ushort v41, v10, s[32:35], s58 offen offset:896
    buffer_load_ushort v42, v10, s[32:35], s58 offen offset:1792
    buffer_load_ushort v43, v10, s[32:35], s58 offen offset:2688
    v_mov_b32 v64, 0
    v_mov_b32 v65, 0
    v_mov_b32 v66, 0
    v_mov_b32 v67, 0
    v_mov_b32 v68, 0
    v_mov_b32 v69, 0
    v_mov_b32 v70, 0
    v_mov_b32 v71, 0
    v_mov_b32 v72, 0
    v_mov_b32 v73, 0
    v_mov_b32 v74, 0
    v_mov_b32 v75, 0
    v_mov_b32 v76, 0
    v_mov_b32 v77, 0
    v_mov_b32 v78, 0
    v_mov_b32 v79, 0
    v_mov_b32 v80, 0
    v_mov_b32 v81, 0
    v_mov_b32 v82, 0
    v_mov_b32 v83, 0
    v_mov_b32 v84, 0
    v_mov_b32 v85, 0
    v_mov_b32 v86, 0
    v_mov_b32 v87, 0
    v_mov_b32 v88, 0
    v_mov_b32 v89, 0
    v_mov_b32 v90, 0
    v_mov_b32 v91, 0
    v_mov_b32 v92, 0
    v_mov_b32 v93, 0
    v_mov_b32 v94, 0
    v_mov_b32 v95, 0
    v_mov_b32 v96, 0
    v_mov_b32 v97, 0
    v_mov_b32 v98, 0
    v_mov_b32 v99, 0
    v_mov_b32 v100, 0
    v_mov_b32 v101, 0
    v_mov_b32 v102, 0
    v_mov_b32 v103, 0
    v_mov_b32 v104, 0
    v_mov_b32 v105, 0
    v_mov_b32 v106, 0
    v_mov_b32 v107, 0
    v_mov_b32 v108, 0
    v_mov_b32 v109, 0
    v_mov_b32 v110, 0
    v_mov_b32 v111, 0
    v_mov_b32 v112, 0
    v_mov_b32 v113, 0
    v_mov_b32 v114, 0
    v_mov_b32 v115, 0
    v_mov_b32 v116, 0
    v_mov_b32 v117, 0
    v_mov_b32 v118, 0
    v_mov_b32 v119, 0
    v_mov_b32 v120, 0
    v_mov_b32 v121, 0
    v_mov_b32 v122, 0
    v_mov_b32 v123, 0
    v_mov_b32 v124, 0
    v_mov_b32 v125, 0
    v_mov_b32 v126, 0
    v_mov_b32 v127, 0
    v_mov_b32 v128, 0
    v_mov_b32 v129, 0
    v_mov_b32 v130, 0
    v_mov_b32 v131, 0
    v_mov_b32 v132, 0
    v_mov_b32 v133, 0
    v_mov_b32 v134, 0
    v_mov_b32 v135, 0
    v_mov_b32 v136, 0
    v_mov_b32 v137, 0
    v_mov_b32 v138, 0
    v_mov_b32 v139, 0
    v_mov_b32 v140, 0
    v_mov_b32 v141, 0
    v_mov_b32 v142, 0
    v_mov_b32 v143, 0
    v_mov_b32 v144, 0
    v_mov_b32 v145, 0
    v_mov_b32 v146, 0
    v_mov_b32 v147, 0
    v_mov_b32 v148, 0
    v_mov_b32 v149, 0
    v_mov_b32 v150, 0
    v_mov_b32 v151, 0
    v_mov_b32 v152, 0
    v_mov_b32 v153, 0
    v_mov_b32 v154, 0
    v_mov_b32 v155, 0
    v_mov_b32 v156, 0
    v_mov_b32 v157, 0
    v_mov_b32 v158, 0
    v_mov_b32 v159, 0
    s_waitcnt vmcnt(8)
    v_mov_b32 v44, 0
    v_lshlrev_b32 v45, 16, v20
    v_and_b32 v46, 0xffff0000, v20
    v_lshlrev_b32 v47, 16, v28
    v_and_b32 v48, 0xffff0000, v28
    v_mul_f32 v45, v45, v47
    v_mul_f32 v46, v46, v48
    v_cvt_pk_bf16_f32 v45, v45, v46
    v_lshlrev_b32 v46, 16, v45
    v_and_b32 v45, 0xffff0000, v45
    v_add_f32 v44, v44, v46
    v_add_f32 v44, v44, v45
    v_lshlrev_b32 v45, 16, v21
    v_and_b32 v46, 0xffff0000, v21
    v_lshlrev_b32 v47, 16, v29
    v_and_b32 v48, 0xffff0000, v29
    v_mul_f32 v45, v45, v47
    v_mul_f32 v46, v46, v48
    v_cvt_pk_bf16_f32 v45, v45, v46
    v_lshlrev_b32 v46, 16, v45
    v_and_b32 v45, 0xffff0000, v45
    v_add_f32 v44, v44, v46
    v_add_f32 v44, v44, v45
    v_lshlrev_b32 v45, 16, v22
    v_and_b32 v46, 0xffff0000, v22
    v_lshlrev_b32 v47, 16, v30
    v_and_b32 v48, 0xffff0000, v30
    v_mul_f32 v45, v45, v47
    v_mul_f32 v46, v46, v48
    v_cvt_pk_bf16_f32 v45, v45, v46
    v_lshlrev_b32 v46, 16, v45
    v_and_b32 v45, 0xffff0000, v45
    v_add_f32 v44, v44, v46
    v_add_f32 v44, v44, v45
    v_lshlrev_b32 v45, 16, v23
    v_and_b32 v46, 0xffff0000, v23
    v_lshlrev_b32 v47, 16, v31
    v_and_b32 v48, 0xffff0000, v31
    v_mul_f32 v45, v45, v47
    v_mul_f32 v46, v46, v48
    v_cvt_pk_bf16_f32 v45, v45, v46
    v_lshlrev_b32 v46, 16, v45
    v_and_b32 v45, 0xffff0000, v45
    v_add_f32 v44, v44, v46
    v_add_f32 v44, v44, v45
    v_lshlrev_b32 v45, 16, v24
    v_and_b32 v46, 0xffff0000, v24
    v_lshlrev_b32 v47, 16, v32
    v_and_b32 v48, 0xffff0000, v32
    v_mul_f32 v45, v45, v47
    v_mul_f32 v46, v46, v48
    v_cvt_pk_bf16_f32 v45, v45, v46
    v_lshlrev_b32 v46, 16, v45
    v_and_b32 v45, 0xffff0000, v45
    v_add_f32 v44, v44, v46
    v_add_f32 v44, v44, v45
    v_lshlrev_b32 v45, 16, v25
    v_and_b32 v46, 0xffff0000, v25
    v_lshlrev_b32 v47, 16, v33
    v_and_b32 v48, 0xffff0000, v33
    v_mul_f32 v45, v45, v47
    v_mul_f32 v46, v46, v48
    v_cvt_pk_bf16_f32 v45, v45, v46
    v_lshlrev_b32 v46, 16, v45
    v_and_b32 v45, 0xffff0000, v45
    v_add_f32 v44, v44, v46
    v_add_f32 v44, v44, v45
    v_lshlrev_b32 v45, 16, v26
    v_and_b32 v46, 0xffff0000, v26
    v_lshlrev_b32 v47, 16, v34
    v_and_b32 v48, 0xffff0000, v34
    v_mul_f32 v45, v45, v47
    v_mul_f32 v46, v46, v48
    v_cvt_pk_bf16_f32 v45, v45, v46
    v_lshlrev_b32 v46, 16, v45
    v_and_b32 v45, 0xffff0000, v45
    v_add_f32 v44, v44, v46
    v_add_f32 v44, v44, v45
    v_lshlrev_b32 v45, 16, v27
    v_and_b32 v46, 0xffff0000, v27
    v_lshlrev_b32 v47, 16, v35
    v_and_b32 v48, 0xffff0000, v35
    v_mul_f32 v45, v45, v47
    v_mul_f32 v46, v46, v48
    v_cvt_pk_bf16_f32 v45, v45, v46
    v_lshlrev_b32 v46, 16, v45
    v_and_b32 v45, 0xffff0000, v45
    v_add_f32 v44, v44, v46
    v_add_f32 v44, v44, v45
    ds_swizzle_b32 v45, v44 offset:1055
    s_waitcnt lgkmcnt(0)
    v_add_f32 v44, v44, v45
    ds_swizzle_b32 v45, v44 offset:2079
    s_waitcnt lgkmcnt(0)
    v_add_f32 v44, v44, v45
    ds_swizzle_b32 v45, v44 offset:4127
    s_waitcnt lgkmcnt(0)
    v_add_f32 v44, v44, v45
    ds_swizzle_b32 v45, v44 offset:8223
    s_waitcnt lgkmcnt(0)
    v_add_f32 v44, v44, v45
    ds_swizzle_b32 v45, v44 offset:16415
    s_waitcnt lgkmcnt(0)
    v_add_f32 v44, v44, v45
    v_cvt_pk_bf16_f32 v44, v44, v44
    v_lshlrev_b32 v44, 16, v44
    v_mul_f32 v44, 3216550459, v44
    v_exp_f32 v44, v44
    s_nop 0
    v_add_f32 v44, 1.0, v44
    v_rcp_f32 v44, v44
    s_nop 0
    v_cvt_pk_bf16_f32 v44, v44, v44
    v_lshlrev_b32 v44, 16, v44
    v_lshlrev_b32 v45, 2, v5
    v_add_u32 v45, 17825792, v45
    v_cmp_eq_u32 vcc, 0, v3
    s_nop 1
    v_cndmask_b32 v45, v8, v45, vcc
    buffer_store_dword v44, v45, s[16:19], 0 offen
    s_waitcnt vmcnt(1)
    v_lshl_or_b32 v44, v37, 16, v36
    v_lshl_or_b32 v45, v39, 16, v38
    v_lshl_or_b32 v46, v41, 16, v40
    v_lshl_or_b32 v47, v43, 16, v42
    s_lshl_b32 s51, s2, 12
    s_add_u32 s51, s51, 16777216
    s_add_u32 s51, s51, s58
    v_lshlrev_b32 v48, 4, v0
    buffer_store_dwordx4 v[44:47], v48, s[16:19], s51 offen
    v_and_b32 v3, 31, v2
    v_lshrrev_b32 v4, 5, v2
    v_bfe_u32 v5, v3, 1, 3
    s_lshl_b32 s51, s49, 13
    v_lshlrev_b32 v6, 7, v3
    v_add_u32 v6, s51, v6
    v_add_u32 v7, 0, v4
    v_xor_b32 v7, v7, v5
    v_lshl_add_u32 v8, v7, 4, v6
    v_add_u32 v7, 2, v4
    v_xor_b32 v7, v7, v5
    v_lshl_add_u32 v9, v7, 4, v6
    v_add_u32 v7, 4, v4
    v_xor_b32 v7, v7, v5
    v_lshl_add_u32 v10, v7, 4, v6
    v_add_u32 v7, 6, v4
    v_xor_b32 v7, v7, v5
    v_lshl_add_u32 v11, v7, 4, v6
    v_bfe_u32 v5, v2, 2, 2
    v_lshlrev_b32 v5, 2, v5
    v_lshl_add_u32 v5, v4, 1, v5
    v_mul_u32_u24 v5, 336, v5
    v_bfe_u32 v6, v2, 4, 1
    v_lshl_add_u32 v5, v6, 5, v5
    v_and_b32 v6, 3, v2
    v_lshl_add_u32 v5, v6, 3, v5
    s_mul_i32 s51, s50, 56
    s_add_u32 s51, s51, 16384
    v_add_u32 v12, s51, v5
    v_add_u32 v13, 0, v8
    v_add_u32 v14, 0, v9
    v_add_u32 v15, 0, v10
    v_add_u32 v16, 0, v11
    v_add_u32 v17, 0, v12
    s_barrier
    ds_read_b128 v[18:21], v13 offset:0
    ds_read_b128 v[22:25], v13 offset:4096
    ds_read_b64_tr_b16 v[34:35], v17 offset:0
    ds_read_b64_tr_b16 v[36:37], v17 offset:336
    ds_read_b64_tr_b16 v[38:39], v17 offset:112
    ds_read_b64_tr_b16 v[40:41], v17 offset:448
    ds_read_b64_tr_b16 v[42:43], v17 offset:224
    ds_read_b64_tr_b16 v[44:45], v17 offset:560
    s_waitcnt lgkmcnt(0)
    v_mfma_f32_32x32x16_bf16 v[64:79], v[34:37], v[18:21], v[64:79]
    ds_read_b128 v[26:29], v14 offset:0
    ds_read_b128 v[30:33], v14 offset:4096
    v_mfma_f32_32x32x16_bf16 v[80:95], v[34:37], v[22:25], v[80:95]
    ds_read_b64_tr_b16 v[46:47], v17 offset:5376
    ds_read_b64_tr_b16 v[48:49], v17 offset:5712
    v_mfma_f32_32x32x16_bf16 v[96:111], v[38:41], v[18:21], v[96:111]
    ds_read_b64_tr_b16 v[50:51], v17 offset:5488
    ds_read_b64_tr_b16 v[52:53], v17 offset:5824
    v_mfma_f32_32x32x16_bf16 v[112:127], v[38:41], v[22:25], v[112:127]
    ds_read_b64_tr_b16 v[54:55], v17 offset:5600
    ds_read_b64_tr_b16 v[56:57], v17 offset:5936
    v_mfma_f32_32x32x16_bf16 v[128:143], v[18:21], v[42:45], v[128:143]
    v_mfma_f32_32x32x16_bf16 v[144:159], v[22:25], v[42:45], v[144:159]
    s_waitcnt lgkmcnt(0)
    v_mfma_f32_32x32x16_bf16 v[64:79], v[46:49], v[26:29], v[64:79]
    ds_read_b128 v[18:21], v15 offset:0
    ds_read_b128 v[22:25], v15 offset:4096
    v_mfma_f32_32x32x16_bf16 v[80:95], v[46:49], v[30:33], v[80:95]
    ds_read_b64_tr_b16 v[34:35], v17 offset:10752
    ds_read_b64_tr_b16 v[36:37], v17 offset:11088
    v_mfma_f32_32x32x16_bf16 v[96:111], v[50:53], v[26:29], v[96:111]
    ds_read_b64_tr_b16 v[38:39], v17 offset:10864
    ds_read_b64_tr_b16 v[40:41], v17 offset:11200
    v_mfma_f32_32x32x16_bf16 v[112:127], v[50:53], v[30:33], v[112:127]
    ds_read_b64_tr_b16 v[42:43], v17 offset:10976
    ds_read_b64_tr_b16 v[44:45], v17 offset:11312
    v_mfma_f32_32x32x16_bf16 v[128:143], v[26:29], v[54:57], v[128:143]
    v_mfma_f32_32x32x16_bf16 v[144:159], v[30:33], v[54:57], v[144:159]
    s_waitcnt lgkmcnt(0)
    v_mfma_f32_32x32x16_bf16 v[64:79], v[34:37], v[18:21], v[64:79]
    ds_read_b128 v[26:29], v16 offset:0
    ds_read_b128 v[30:33], v16 offset:4096
    v_mfma_f32_32x32x16_bf16 v[80:95], v[34:37], v[22:25], v[80:95]
    ds_read_b64_tr_b16 v[46:47], v17 offset:16128
    ds_read_b64_tr_b16 v[48:49], v17 offset:16464
    v_mfma_f32_32x32x16_bf16 v[96:111], v[38:41], v[18:21], v[96:111]
    ds_read_b64_tr_b16 v[50:51], v17 offset:16240
    ds_read_b64_tr_b16 v[52:53], v17 offset:16576
    v_mfma_f32_32x32x16_bf16 v[112:127], v[38:41], v[22:25], v[112:127]
    ds_read_b64_tr_b16 v[54:55], v17 offset:16352
    ds_read_b64_tr_b16 v[56:57], v17 offset:16688
    v_mfma_f32_32x32x16_bf16 v[128:143], v[18:21], v[42:45], v[128:143]
    v_mfma_f32_32x32x16_bf16 v[144:159], v[22:25], v[42:45], v[144:159]
    s_waitcnt lgkmcnt(0)
    s_barrier
    v_add_u32 v13, 40960, v8
    v_add_u32 v14, 40960, v9
    v_add_u32 v15, 40960, v10
    v_add_u32 v16, 40960, v11
    v_add_u32 v17, 40960, v12
    v_mfma_f32_32x32x16_bf16 v[64:79], v[46:49], v[26:29], v[64:79]
    ds_read_b128 v[18:21], v13 offset:0
    ds_read_b128 v[22:25], v13 offset:4096
    v_mfma_f32_32x32x16_bf16 v[80:95], v[46:49], v[30:33], v[80:95]
    ds_read_b64_tr_b16 v[34:35], v17 offset:0
    ds_read_b64_tr_b16 v[36:37], v17 offset:336
    v_mfma_f32_32x32x16_bf16 v[96:111], v[50:53], v[26:29], v[96:111]
    ds_read_b64_tr_b16 v[38:39], v17 offset:112
    ds_read_b64_tr_b16 v[40:41], v17 offset:448
    v_mfma_f32_32x32x16_bf16 v[112:127], v[50:53], v[30:33], v[112:127]
    ds_read_b64_tr_b16 v[42:43], v17 offset:224
    ds_read_b64_tr_b16 v[44:45], v17 offset:560
    v_mfma_f32_32x32x16_bf16 v[128:143], v[26:29], v[54:57], v[128:143]
    v_mfma_f32_32x32x16_bf16 v[144:159], v[30:33], v[54:57], v[144:159]
    s_waitcnt lgkmcnt(0)
    v_mfma_f32_32x32x16_bf16 v[64:79], v[34:37], v[18:21], v[64:79]
    ds_read_b128 v[26:29], v14 offset:0
    ds_read_b128 v[30:33], v14 offset:4096
    v_mfma_f32_32x32x16_bf16 v[80:95], v[34:37], v[22:25], v[80:95]
    ds_read_b64_tr_b16 v[46:47], v17 offset:5376
    ds_read_b64_tr_b16 v[48:49], v17 offset:5712
    v_mfma_f32_32x32x16_bf16 v[96:111], v[38:41], v[18:21], v[96:111]
    ds_read_b64_tr_b16 v[50:51], v17 offset:5488
    ds_read_b64_tr_b16 v[52:53], v17 offset:5824
    v_mfma_f32_32x32x16_bf16 v[112:127], v[38:41], v[22:25], v[112:127]
    ds_read_b64_tr_b16 v[54:55], v17 offset:5600
    ds_read_b64_tr_b16 v[56:57], v17 offset:5936
    v_mfma_f32_32x32x16_bf16 v[128:143], v[18:21], v[42:45], v[128:143]
    v_mfma_f32_32x32x16_bf16 v[144:159], v[22:25], v[42:45], v[144:159]
    s_waitcnt lgkmcnt(0)
    v_mfma_f32_32x32x16_bf16 v[64:79], v[46:49], v[26:29], v[64:79]
    ds_read_b128 v[18:21], v15 offset:0
    ds_read_b128 v[22:25], v15 offset:4096
    v_mfma_f32_32x32x16_bf16 v[80:95], v[46:49], v[30:33], v[80:95]
    ds_read_b64_tr_b16 v[34:35], v17 offset:10752
    ds_read_b64_tr_b16 v[36:37], v17 offset:11088
    v_mfma_f32_32x32x16_bf16 v[96:111], v[50:53], v[26:29], v[96:111]
    ds_read_b64_tr_b16 v[38:39], v17 offset:10864
    ds_read_b64_tr_b16 v[40:41], v17 offset:11200
    v_mfma_f32_32x32x16_bf16 v[112:127], v[50:53], v[30:33], v[112:127]
    ds_read_b64_tr_b16 v[42:43], v17 offset:10976
    ds_read_b64_tr_b16 v[44:45], v17 offset:11312
    v_mfma_f32_32x32x16_bf16 v[128:143], v[26:29], v[54:57], v[128:143]
    v_mfma_f32_32x32x16_bf16 v[144:159], v[30:33], v[54:57], v[144:159]
    s_waitcnt lgkmcnt(0)
    v_mfma_f32_32x32x16_bf16 v[64:79], v[34:37], v[18:21], v[64:79]
    ds_read_b128 v[26:29], v16 offset:0
    ds_read_b128 v[30:33], v16 offset:4096
    v_mfma_f32_32x32x16_bf16 v[80:95], v[34:37], v[22:25], v[80:95]
    ds_read_b64_tr_b16 v[46:47], v17 offset:16128
    ds_read_b64_tr_b16 v[48:49], v17 offset:16464
    v_mfma_f32_32x32x16_bf16 v[96:111], v[38:41], v[18:21], v[96:111]
    ds_read_b64_tr_b16 v[50:51], v17 offset:16240
    ds_read_b64_tr_b16 v[52:53], v17 offset:16576
    v_mfma_f32_32x32x16_bf16 v[112:127], v[38:41], v[22:25], v[112:127]
    ds_read_b64_tr_b16 v[54:55], v17 offset:16352
    ds_read_b64_tr_b16 v[56:57], v17 offset:16688
    v_mfma_f32_32x32x16_bf16 v[128:143], v[18:21], v[42:45], v[128:143]
    v_mfma_f32_32x32x16_bf16 v[144:159], v[22:25], v[42:45], v[144:159]
    s_waitcnt lgkmcnt(0)
    s_barrier
    v_add_u32 v13, 81920, v8
    v_add_u32 v14, 81920, v9
    v_add_u32 v15, 81920, v10
    v_add_u32 v16, 81920, v11
    v_add_u32 v17, 81920, v12
    v_mfma_f32_32x32x16_bf16 v[64:79], v[46:49], v[26:29], v[64:79]
    ds_read_b128 v[18:21], v13 offset:0
    ds_read_b128 v[22:25], v13 offset:4096
    v_mfma_f32_32x32x16_bf16 v[80:95], v[46:49], v[30:33], v[80:95]
    ds_read_b64_tr_b16 v[34:35], v17 offset:0
    ds_read_b64_tr_b16 v[36:37], v17 offset:336
    v_mfma_f32_32x32x16_bf16 v[96:111], v[50:53], v[26:29], v[96:111]
    ds_read_b64_tr_b16 v[38:39], v17 offset:112
    ds_read_b64_tr_b16 v[40:41], v17 offset:448
    v_mfma_f32_32x32x16_bf16 v[112:127], v[50:53], v[30:33], v[112:127]
    ds_read_b64_tr_b16 v[42:43], v17 offset:224
    ds_read_b64_tr_b16 v[44:45], v17 offset:560
    v_mfma_f32_32x32x16_bf16 v[128:143], v[26:29], v[54:57], v[128:143]
    v_mfma_f32_32x32x16_bf16 v[144:159], v[30:33], v[54:57], v[144:159]
    s_waitcnt lgkmcnt(0)
    v_mfma_f32_32x32x16_bf16 v[64:79], v[34:37], v[18:21], v[64:79]
    ds_read_b128 v[26:29], v14 offset:0
    ds_read_b128 v[30:33], v14 offset:4096
    v_mfma_f32_32x32x16_bf16 v[80:95], v[34:37], v[22:25], v[80:95]
    ds_read_b64_tr_b16 v[46:47], v17 offset:5376
    ds_read_b64_tr_b16 v[48:49], v17 offset:5712
    v_mfma_f32_32x32x16_bf16 v[96:111], v[38:41], v[18:21], v[96:111]
    ds_read_b64_tr_b16 v[50:51], v17 offset:5488
    ds_read_b64_tr_b16 v[52:53], v17 offset:5824
    v_mfma_f32_32x32x16_bf16 v[112:127], v[38:41], v[22:25], v[112:127]
    ds_read_b64_tr_b16 v[54:55], v17 offset:5600
    ds_read_b64_tr_b16 v[56:57], v17 offset:5936
    v_mfma_f32_32x32x16_bf16 v[128:143], v[18:21], v[42:45], v[128:143]
    v_mfma_f32_32x32x16_bf16 v[144:159], v[22:25], v[42:45], v[144:159]
    s_waitcnt lgkmcnt(0)
    v_mfma_f32_32x32x16_bf16 v[64:79], v[46:49], v[26:29], v[64:79]
    ds_read_b128 v[18:21], v15 offset:0
    ds_read_b128 v[22:25], v15 offset:4096
    v_mfma_f32_32x32x16_bf16 v[80:95], v[46:49], v[30:33], v[80:95]
    ds_read_b64_tr_b16 v[34:35], v17 offset:10752
    ds_read_b64_tr_b16 v[36:37], v17 offset:11088
    v_mfma_f32_32x32x16_bf16 v[96:111], v[50:53], v[26:29], v[96:111]
    ds_read_b64_tr_b16 v[38:39], v17 offset:10864
    ds_read_b64_tr_b16 v[40:41], v17 offset:11200
    v_mfma_f32_32x32x16_bf16 v[112:127], v[50:53], v[30:33], v[112:127]
    ds_read_b64_tr_b16 v[42:43], v17 offset:10976
    ds_read_b64_tr_b16 v[44:45], v17 offset:11312
    v_mfma_f32_32x32x16_bf16 v[128:143], v[26:29], v[54:57], v[128:143]
    v_mfma_f32_32x32x16_bf16 v[144:159], v[30:33], v[54:57], v[144:159]
    s_waitcnt lgkmcnt(0)
    v_mfma_f32_32x32x16_bf16 v[64:79], v[34:37], v[18:21], v[64:79]
    ds_read_b128 v[26:29], v16 offset:0
    ds_read_b128 v[30:33], v16 offset:4096
    v_mfma_f32_32x32x16_bf16 v[80:95], v[34:37], v[22:25], v[80:95]
    ds_read_b64_tr_b16 v[46:47], v17 offset:16128
    ds_read_b64_tr_b16 v[48:49], v17 offset:16464
    v_mfma_f32_32x32x16_bf16 v[96:111], v[38:41], v[18:21], v[96:111]
    ds_read_b64_tr_b16 v[50:51], v17 offset:16240
    ds_read_b64_tr_b16 v[52:53], v17 offset:16576
    v_mfma_f32_32x32x16_bf16 v[112:127], v[38:41], v[22:25], v[112:127]
    ds_read_b64_tr_b16 v[54:55], v17 offset:16352
    ds_read_b64_tr_b16 v[56:57], v17 offset:16688
    v_mfma_f32_32x32x16_bf16 v[128:143], v[18:21], v[42:45], v[128:143]
    v_mfma_f32_32x32x16_bf16 v[144:159], v[22:25], v[42:45], v[144:159]
    s_waitcnt lgkmcnt(0)
    s_barrier
    v_add_u32 v13, 0, v8
    v_add_u32 v14, 0, v9
    v_add_u32 v15, 0, v10
    v_add_u32 v16, 0, v11
    v_add_u32 v17, 0, v12
    v_mfma_f32_32x32x16_bf16 v[64:79], v[46:49], v[26:29], v[64:79]
    ds_read_b128 v[18:21], v13 offset:0
    ds_read_b128 v[22:25], v13 offset:4096
    v_mfma_f32_32x32x16_bf16 v[80:95], v[46:49], v[30:33], v[80:95]
    ds_read_b64_tr_b16 v[34:35], v17 offset:0
    ds_read_b64_tr_b16 v[36:37], v17 offset:336
    v_mfma_f32_32x32x16_bf16 v[96:111], v[50:53], v[26:29], v[96:111]
    ds_read_b64_tr_b16 v[38:39], v17 offset:112
    ds_read_b64_tr_b16 v[40:41], v17 offset:448
    v_mfma_f32_32x32x16_bf16 v[112:127], v[50:53], v[30:33], v[112:127]
    ds_read_b64_tr_b16 v[42:43], v17 offset:224
    ds_read_b64_tr_b16 v[44:45], v17 offset:560
    v_mfma_f32_32x32x16_bf16 v[128:143], v[26:29], v[54:57], v[128:143]
    v_mfma_f32_32x32x16_bf16 v[144:159], v[30:33], v[54:57], v[144:159]
    s_waitcnt lgkmcnt(0)
    v_mfma_f32_32x32x16_bf16 v[64:79], v[34:37], v[18:21], v[64:79]
    ds_read_b128 v[26:29], v14 offset:0
    ds_read_b128 v[30:33], v14 offset:4096
    v_mfma_f32_32x32x16_bf16 v[80:95], v[34:37], v[22:25], v[80:95]
    ds_read_b64_tr_b16 v[46:47], v17 offset:5376
    ds_read_b64_tr_b16 v[48:49], v17 offset:5712
    v_mfma_f32_32x32x16_bf16 v[96:111], v[38:41], v[18:21], v[96:111]
    ds_read_b64_tr_b16 v[50:51], v17 offset:5488
    ds_read_b64_tr_b16 v[52:53], v17 offset:5824
    v_mfma_f32_32x32x16_bf16 v[112:127], v[38:41], v[22:25], v[112:127]
    ds_read_b64_tr_b16 v[54:55], v17 offset:5600
    ds_read_b64_tr_b16 v[56:57], v17 offset:5936
    v_mfma_f32_32x32x16_bf16 v[128:143], v[18:21], v[42:45], v[128:143]
    v_mfma_f32_32x32x16_bf16 v[144:159], v[22:25], v[42:45], v[144:159]
    s_waitcnt lgkmcnt(0)
    v_mfma_f32_32x32x16_bf16 v[64:79], v[46:49], v[26:29], v[64:79]
    ds_read_b128 v[18:21], v15 offset:0
    ds_read_b128 v[22:25], v15 offset:4096
    v_mfma_f32_32x32x16_bf16 v[80:95], v[46:49], v[30:33], v[80:95]
    ds_read_b64_tr_b16 v[34:35], v17 offset:10752
    ds_read_b64_tr_b16 v[36:37], v17 offset:11088
    v_mfma_f32_32x32x16_bf16 v[96:111], v[50:53], v[26:29], v[96:111]
    ds_read_b64_tr_b16 v[38:39], v17 offset:10864
    ds_read_b64_tr_b16 v[40:41], v17 offset:11200
    v_mfma_f32_32x32x16_bf16 v[112:127], v[50:53], v[30:33], v[112:127]
    ds_read_b64_tr_b16 v[42:43], v17 offset:10976
    ds_read_b64_tr_b16 v[44:45], v17 offset:11312
    v_mfma_f32_32x32x16_bf16 v[128:143], v[26:29], v[54:57], v[128:143]
    v_mfma_f32_32x32x16_bf16 v[144:159], v[30:33], v[54:57], v[144:159]
    s_waitcnt lgkmcnt(0)
    v_mfma_f32_32x32x16_bf16 v[64:79], v[34:37], v[18:21], v[64:79]
    ds_read_b128 v[26:29], v16 offset:0
    ds_read_b128 v[30:33], v16 offset:4096
    v_mfma_f32_32x32x16_bf16 v[80:95], v[34:37], v[22:25], v[80:95]
    ds_read_b64_tr_b16 v[46:47], v17 offset:16128
    ds_read_b64_tr_b16 v[48:49], v17 offset:16464
    v_mfma_f32_32x32x16_bf16 v[96:111], v[38:41], v[18:21], v[96:111]
    ds_read_b64_tr_b16 v[50:51], v17 offset:16240
    ds_read_b64_tr_b16 v[52:53], v17 offset:16576
    v_mfma_f32_32x32x16_bf16 v[112:127], v[38:41], v[22:25], v[112:127]
    ds_read_b64_tr_b16 v[54:55], v17 offset:16352
    ds_read_b64_tr_b16 v[56:57], v17 offset:16688
    v_mfma_f32_32x32x16_bf16 v[128:143], v[18:21], v[42:45], v[128:143]
    v_mfma_f32_32x32x16_bf16 v[144:159], v[22:25], v[42:45], v[144:159]
    s_waitcnt lgkmcnt(0)
    s_barrier
    v_add_u32 v13, 40960, v8
    v_add_u32 v14, 40960, v9
    v_add_u32 v15, 40960, v10
    v_add_u32 v16, 40960, v11
    v_add_u32 v17, 40960, v12
    v_mfma_f32_32x32x16_bf16 v[64:79], v[46:49], v[26:29], v[64:79]
    ds_read_b128 v[18:21], v13 offset:0
    ds_read_b128 v[22:25], v13 offset:4096
    v_mfma_f32_32x32x16_bf16 v[80:95], v[46:49], v[30:33], v[80:95]
    ds_read_b64_tr_b16 v[34:35], v17 offset:0
    ds_read_b64_tr_b16 v[36:37], v17 offset:336
    v_mfma_f32_32x32x16_bf16 v[96:111], v[50:53], v[26:29], v[96:111]
    ds_read_b64_tr_b16 v[38:39], v17 offset:112
    ds_read_b64_tr_b16 v[40:41], v17 offset:448
    v_mfma_f32_32x32x16_bf16 v[112:127], v[50:53], v[30:33], v[112:127]
    ds_read_b64_tr_b16 v[42:43], v17 offset:224
    ds_read_b64_tr_b16 v[44:45], v17 offset:560
    v_mfma_f32_32x32x16_bf16 v[128:143], v[26:29], v[54:57], v[128:143]
    v_mfma_f32_32x32x16_bf16 v[144:159], v[30:33], v[54:57], v[144:159]
    s_waitcnt lgkmcnt(0)
    v_mfma_f32_32x32x16_bf16 v[64:79], v[34:37], v[18:21], v[64:79]
    ds_read_b128 v[26:29], v14 offset:0
    ds_read_b128 v[30:33], v14 offset:4096
    v_mfma_f32_32x32x16_bf16 v[80:95], v[34:37], v[22:25], v[80:95]
    ds_read_b64_tr_b16 v[46:47], v17 offset:5376
    ds_read_b64_tr_b16 v[48:49], v17 offset:5712
    v_mfma_f32_32x32x16_bf16 v[96:111], v[38:41], v[18:21], v[96:111]
    ds_read_b64_tr_b16 v[50:51], v17 offset:5488
    ds_read_b64_tr_b16 v[52:53], v17 offset:5824
    v_mfma_f32_32x32x16_bf16 v[112:127], v[38:41], v[22:25], v[112:127]
    ds_read_b64_tr_b16 v[54:55], v17 offset:5600
    ds_read_b64_tr_b16 v[56:57], v17 offset:5936
    v_mfma_f32_32x32x16_bf16 v[128:143], v[18:21], v[42:45], v[128:143]
    v_mfma_f32_32x32x16_bf16 v[144:159], v[22:25], v[42:45], v[144:159]
    s_waitcnt lgkmcnt(0)
    v_mfma_f32_32x32x16_bf16 v[64:79], v[46:49], v[26:29], v[64:79]
    ds_read_b128 v[18:21], v15 offset:0
    ds_read_b128 v[22:25], v15 offset:4096
    v_mfma_f32_32x32x16_bf16 v[80:95], v[46:49], v[30:33], v[80:95]
    ds_read_b64_tr_b16 v[34:35], v17 offset:10752
    ds_read_b64_tr_b16 v[36:37], v17 offset:11088
    v_mfma_f32_32x32x16_bf16 v[96:111], v[50:53], v[26:29], v[96:111]
    ds_read_b64_tr_b16 v[38:39], v17 offset:10864
    ds_read_b64_tr_b16 v[40:41], v17 offset:11200
    v_mfma_f32_32x32x16_bf16 v[112:127], v[50:53], v[30:33], v[112:127]
    ds_read_b64_tr_b16 v[42:43], v17 offset:10976
    ds_read_b64_tr_b16 v[44:45], v17 offset:11312
    v_mfma_f32_32x32x16_bf16 v[128:143], v[26:29], v[54:57], v[128:143]
    v_mfma_f32_32x32x16_bf16 v[144:159], v[30:33], v[54:57], v[144:159]
    s_waitcnt lgkmcnt(0)
    v_mfma_f32_32x32x16_bf16 v[64:79], v[34:37], v[18:21], v[64:79]
    ds_read_b128 v[26:29], v16 offset:0
    ds_read_b128 v[30:33], v16 offset:4096
    v_mfma_f32_32x32x16_bf16 v[80:95], v[34:37], v[22:25], v[80:95]
    ds_read_b64_tr_b16 v[46:47], v17 offset:16128
    ds_read_b64_tr_b16 v[48:49], v17 offset:16464
    v_mfma_f32_32x32x16_bf16 v[96:111], v[38:41], v[18:21], v[96:111]
    ds_read_b64_tr_b16 v[50:51], v17 offset:16240
    ds_read_b64_tr_b16 v[52:53], v17 offset:16576
    v_mfma_f32_32x32x16_bf16 v[112:127], v[38:41], v[22:25], v[112:127]
    ds_read_b64_tr_b16 v[54:55], v17 offset:16352
    ds_read_b64_tr_b16 v[56:57], v17 offset:16688
    v_mfma_f32_32x32x16_bf16 v[128:143], v[18:21], v[42:45], v[128:143]
    v_mfma_f32_32x32x16_bf16 v[144:159], v[22:25], v[42:45], v[144:159]
    s_waitcnt lgkmcnt(0)
    s_barrier
    v_add_u32 v13, 81920, v8
    v_add_u32 v14, 81920, v9
    v_add_u32 v15, 81920, v10
    v_add_u32 v16, 81920, v11
    v_add_u32 v17, 81920, v12
    v_mfma_f32_32x32x16_bf16 v[64:79], v[46:49], v[26:29], v[64:79]
    ds_read_b128 v[18:21], v13 offset:0
    ds_read_b128 v[22:25], v13 offset:4096
    v_mfma_f32_32x32x16_bf16 v[80:95], v[46:49], v[30:33], v[80:95]
    ds_read_b64_tr_b16 v[34:35], v17 offset:0
    ds_read_b64_tr_b16 v[36:37], v17 offset:336
    v_mfma_f32_32x32x16_bf16 v[96:111], v[50:53], v[26:29], v[96:111]
    ds_read_b64_tr_b16 v[38:39], v17 offset:112
    ds_read_b64_tr_b16 v[40:41], v17 offset:448
    v_mfma_f32_32x32x16_bf16 v[112:127], v[50:53], v[30:33], v[112:127]
    ds_read_b64_tr_b16 v[42:43], v17 offset:224
    ds_read_b64_tr_b16 v[44:45], v17 offset:560
    v_mfma_f32_32x32x16_bf16 v[128:143], v[26:29], v[54:57], v[128:143]
    v_mfma_f32_32x32x16_bf16 v[144:159], v[30:33], v[54:57], v[144:159]
    s_waitcnt lgkmcnt(0)
    v_mfma_f32_32x32x16_bf16 v[64:79], v[34:37], v[18:21], v[64:79]
    ds_read_b128 v[26:29], v14 offset:0
    ds_read_b128 v[30:33], v14 offset:4096
    v_mfma_f32_32x32x16_bf16 v[80:95], v[34:37], v[22:25], v[80:95]
    ds_read_b64_tr_b16 v[46:47], v17 offset:5376
    ds_read_b64_tr_b16 v[48:49], v17 offset:5712
    v_mfma_f32_32x32x16_bf16 v[96:111], v[38:41], v[18:21], v[96:111]
    ds_read_b64_tr_b16 v[50:51], v17 offset:5488
    ds_read_b64_tr_b16 v[52:53], v17 offset:5824
    v_mfma_f32_32x32x16_bf16 v[112:127], v[38:41], v[22:25], v[112:127]
    ds_read_b64_tr_b16 v[54:55], v17 offset:5600
    ds_read_b64_tr_b16 v[56:57], v17 offset:5936
    v_mfma_f32_32x32x16_bf16 v[128:143], v[18:21], v[42:45], v[128:143]
    v_mfma_f32_32x32x16_bf16 v[144:159], v[22:25], v[42:45], v[144:159]
    s_waitcnt lgkmcnt(0)
    v_mfma_f32_32x32x16_bf16 v[64:79], v[46:49], v[26:29], v[64:79]
    ds_read_b128 v[18:21], v15 offset:0
    ds_read_b128 v[22:25], v15 offset:4096
    v_mfma_f32_32x32x16_bf16 v[80:95], v[46:49], v[30:33], v[80:95]
    ds_read_b64_tr_b16 v[34:35], v17 offset:10752
    ds_read_b64_tr_b16 v[36:37], v17 offset:11088
    v_mfma_f32_32x32x16_bf16 v[96:111], v[50:53], v[26:29], v[96:111]
    ds_read_b64_tr_b16 v[38:39], v17 offset:10864
    ds_read_b64_tr_b16 v[40:41], v17 offset:11200
    v_mfma_f32_32x32x16_bf16 v[112:127], v[50:53], v[30:33], v[112:127]
    ds_read_b64_tr_b16 v[42:43], v17 offset:10976
    ds_read_b64_tr_b16 v[44:45], v17 offset:11312
    v_mfma_f32_32x32x16_bf16 v[128:143], v[26:29], v[54:57], v[128:143]
    v_mfma_f32_32x32x16_bf16 v[144:159], v[30:33], v[54:57], v[144:159]
    s_waitcnt lgkmcnt(0)
    v_mfma_f32_32x32x16_bf16 v[64:79], v[34:37], v[18:21], v[64:79]
    ds_read_b128 v[26:29], v16 offset:0
    ds_read_b128 v[30:33], v16 offset:4096
    v_mfma_f32_32x32x16_bf16 v[80:95], v[34:37], v[22:25], v[80:95]
    ds_read_b64_tr_b16 v[46:47], v17 offset:16128
    ds_read_b64_tr_b16 v[48:49], v17 offset:16464
    v_mfma_f32_32x32x16_bf16 v[96:111], v[38:41], v[18:21], v[96:111]
    ds_read_b64_tr_b16 v[50:51], v17 offset:16240
    ds_read_b64_tr_b16 v[52:53], v17 offset:16576
    v_mfma_f32_32x32x16_bf16 v[112:127], v[38:41], v[22:25], v[112:127]
    ds_read_b64_tr_b16 v[54:55], v17 offset:16352
    ds_read_b64_tr_b16 v[56:57], v17 offset:16688
    v_mfma_f32_32x32x16_bf16 v[128:143], v[18:21], v[42:45], v[128:143]
    v_mfma_f32_32x32x16_bf16 v[144:159], v[22:25], v[42:45], v[144:159]
    s_waitcnt lgkmcnt(0)
    s_barrier
    v_add_u32 v13, 0, v8
    v_add_u32 v14, 0, v9
    v_add_u32 v15, 0, v10
    v_add_u32 v16, 0, v11
    v_add_u32 v17, 0, v12
    v_mfma_f32_32x32x16_bf16 v[64:79], v[46:49], v[26:29], v[64:79]
    ds_read_b128 v[18:21], v13 offset:0
    ds_read_b128 v[22:25], v13 offset:4096
    v_mfma_f32_32x32x16_bf16 v[80:95], v[46:49], v[30:33], v[80:95]
    ds_read_b64_tr_b16 v[34:35], v17 offset:0
    ds_read_b64_tr_b16 v[36:37], v17 offset:336
    v_mfma_f32_32x32x16_bf16 v[96:111], v[50:53], v[26:29], v[96:111]
    ds_read_b64_tr_b16 v[38:39], v17 offset:112
    ds_read_b64_tr_b16 v[40:41], v17 offset:448
    v_mfma_f32_32x32x16_bf16 v[112:127], v[50:53], v[30:33], v[112:127]
    ds_read_b64_tr_b16 v[42:43], v17 offset:224
    ds_read_b64_tr_b16 v[44:45], v17 offset:560
    v_mfma_f32_32x32x16_bf16 v[128:143], v[26:29], v[54:57], v[128:143]
    v_mfma_f32_32x32x16_bf16 v[144:159], v[30:33], v[54:57], v[144:159]
    s_waitcnt lgkmcnt(0)
    v_mfma_f32_32x32x16_bf16 v[64:79], v[34:37], v[18:21], v[64:79]
    ds_read_b128 v[26:29], v14 offset:0
    ds_read_b128 v[30:33], v14 offset:4096
    v_mfma_f32_32x32x16_bf16 v[80:95], v[34:37], v[22:25], v[80:95]
    ds_read_b64_tr_b16 v[46:47], v17 offset:5376
    ds_read_b64_tr_b16 v[48:49], v17 offset:5712
    v_mfma_f32_32x32x16_bf16 v[96:111], v[38:41], v[18:21], v[96:111]
    ds_read_b64_tr_b16 v[50:51], v17 offset:5488
    ds_read_b64_tr_b16 v[52:53], v17 offset:5824
    v_mfma_f32_32x32x16_bf16 v[112:127], v[38:41], v[22:25], v[112:127]
    ds_read_b64_tr_b16 v[54:55], v17 offset:5600
    ds_read_b64_tr_b16 v[56:57], v17 offset:5936
    v_mfma_f32_32x32x16_bf16 v[128:143], v[18:21], v[42:45], v[128:143]
    v_mfma_f32_32x32x16_bf16 v[144:159], v[22:25], v[42:45], v[144:159]
    s_waitcnt lgkmcnt(0)
    v_mfma_f32_32x32x16_bf16 v[64:79], v[46:49], v[26:29], v[64:79]
    ds_read_b128 v[18:21], v15 offset:0
    ds_read_b128 v[22:25], v15 offset:4096
    v_mfma_f32_32x32x16_bf16 v[80:95], v[46:49], v[30:33], v[80:95]
    ds_read_b64_tr_b16 v[34:35], v17 offset:10752
    ds_read_b64_tr_b16 v[36:37], v17 offset:11088
    v_mfma_f32_32x32x16_bf16 v[96:111], v[50:53], v[26:29], v[96:111]
    ds_read_b64_tr_b16 v[38:39], v17 offset:10864
    ds_read_b64_tr_b16 v[40:41], v17 offset:11200
    v_mfma_f32_32x32x16_bf16 v[112:127], v[50:53], v[30:33], v[112:127]
    ds_read_b64_tr_b16 v[42:43], v17 offset:10976
    ds_read_b64_tr_b16 v[44:45], v17 offset:11312
    v_mfma_f32_32x32x16_bf16 v[128:143], v[26:29], v[54:57], v[128:143]
    v_mfma_f32_32x32x16_bf16 v[144:159], v[30:33], v[54:57], v[144:159]
    s_waitcnt lgkmcnt(0)
    v_mfma_f32_32x32x16_bf16 v[64:79], v[34:37], v[18:21], v[64:79]
    ds_read_b128 v[26:29], v16 offset:0
    ds_read_b128 v[30:33], v16 offset:4096
    v_mfma_f32_32x32x16_bf16 v[80:95], v[34:37], v[22:25], v[80:95]
    ds_read_b64_tr_b16 v[46:47], v17 offset:16128
    ds_read_b64_tr_b16 v[48:49], v17 offset:16464
    v_mfma_f32_32x32x16_bf16 v[96:111], v[38:41], v[18:21], v[96:111]
    ds_read_b64_tr_b16 v[50:51], v17 offset:16240
    ds_read_b64_tr_b16 v[52:53], v17 offset:16576
    v_mfma_f32_32x32x16_bf16 v[112:127], v[38:41], v[22:25], v[112:127]
    ds_read_b64_tr_b16 v[54:55], v17 offset:16352
    ds_read_b64_tr_b16 v[56:57], v17 offset:16688
    v_mfma_f32_32x32x16_bf16 v[128:143], v[18:21], v[42:45], v[128:143]
    v_mfma_f32_32x32x16_bf16 v[144:159], v[22:25], v[42:45], v[144:159]
    s_waitcnt lgkmcnt(0)
    v_mfma_f32_32x32x16_bf16 v[64:79], v[46:49], v[26:29], v[64:79]
    v_mfma_f32_32x32x16_bf16 v[80:95], v[46:49], v[30:33], v[80:95]
    v_mfma_f32_32x32x16_bf16 v[96:111], v[50:53], v[26:29], v[96:111]
    v_mfma_f32_32x32x16_bf16 v[112:127], v[50:53], v[30:33], v[112:127]
    v_mfma_f32_32x32x16_bf16 v[128:143], v[26:29], v[54:57], v[128:143]
    v_mfma_f32_32x32x16_bf16 v[144:159], v[30:33], v[54:57], v[144:159]
    s_lshl_b32 s51, s47, 1
    s_add_u32 s51, s51, s50
    s_lshl_b32 s52, s46, 4
    s_add_u32 s51, s51, s52
    s_lshl_b32 s51, s51, 17
    s_lshl_b32 s52, s44, 2
    s_lshl_b32 s53, s49, 1
    s_add_u32 s52, s52, s53
    s_lshl_b32 s52, s52, 11
    s_add_u32 s51, s51, s52
    v_lshlrev_b32 v3, 4, v2
    s_mov_b32 s56, 1049335798
    v_cmp_gt_u32 s[60:61], 32, v2
    v_and_b32 v4, 31, v2
    v_cmp_eq_u32 s[62:63], 28, v4
    v_mov_b32 v5, 0
    v_mov_b32 v6, 0x3f803f80
    s_add_u32 s52, s51, 0
    v_mul_f32 v64, s56, v64
    v_mul_f32 v65, s56, v65
    v_mul_f32 v66, s56, v66
    v_mul_f32 v67, s56, v67
    v_mul_f32 v68, s56, v68
    v_mul_f32 v69, s56, v69
    v_mul_f32 v70, s56, v70
    v_mul_f32 v71, s56, v71
    v_mul_f32 v72, s56, v72
    v_mul_f32 v73, s56, v73
    v_mul_f32 v74, s56, v74
    v_mul_f32 v75, s56, v75
    v_mul_f32 v76, s56, v76
    v_mul_f32 v77, s56, v77
    v_mul_f32 v78, s56, v78
    v_mul_f32 v79, s56, v79
    v_cvt_pk_bf16_f32 v64, v64, v65
    v_cvt_pk_bf16_f32 v65, v66, v67
    v_cvt_pk_bf16_f32 v66, v68, v69
    v_cvt_pk_bf16_f32 v67, v70, v71
    v_cvt_pk_bf16_f32 v68, v72, v73
    v_cvt_pk_bf16_f32 v69, v74, v75
    v_cvt_pk_bf16_f32 v70, v76, v77
    v_cvt_pk_bf16_f32 v71, v78, v79
    v_cndmask_b32 v70, v5, v70, s[60:61]
    v_cndmask_b32 v71, v5, v71, s[60:61]
    buffer_store_dwordx4 v[64:67], v3, s[16:19], s52 offen offset:0 sc1
    buffer_store_dwordx4 v[68:71], v3, s[16:19], s52 offen offset:1024 sc1
    v_mul_f32 v80, s56, v80
    v_mul_f32 v81, s56, v81
    v_mul_f32 v82, s56, v82
    v_mul_f32 v83, s56, v83
    v_mul_f32 v84, s56, v84
    v_mul_f32 v85, s56, v85
    v_mul_f32 v86, s56, v86
    v_mul_f32 v87, s56, v87
    v_mul_f32 v88, s56, v88
    v_mul_f32 v89, s56, v89
    v_mul_f32 v90, s56, v90
    v_mul_f32 v91, s56, v91
    v_mul_f32 v92, s56, v92
    v_mul_f32 v93, s56, v93
    v_mul_f32 v94, s56, v94
    v_mul_f32 v95, s56, v95
    v_cvt_pk_bf16_f32 v80, v80, v81
    v_cvt_pk_bf16_f32 v81, v82, v83
    v_cvt_pk_bf16_f32 v82, v84, v85
    v_cvt_pk_bf16_f32 v83, v86, v87
    v_cvt_pk_bf16_f32 v84, v88, v89
    v_cvt_pk_bf16_f32 v85, v90, v91
    v_cvt_pk_bf16_f32 v86, v92, v93
    v_cvt_pk_bf16_f32 v87, v94, v95
    v_cndmask_b32 v86, v5, v86, s[60:61]
    v_cndmask_b32 v87, v5, v87, s[60:61]
    buffer_store_dwordx4 v[80:83], v3, s[16:19], s52 offen offset:2048 sc1
    buffer_store_dwordx4 v[84:87], v3, s[16:19], s52 offen offset:3072 sc1
    s_add_u32 s52, s51, 4194304
    v_cvt_pk_bf16_f32 v96, v96, v97
    v_cvt_pk_bf16_f32 v97, v98, v99
    v_cvt_pk_bf16_f32 v98, v100, v101
    v_cvt_pk_bf16_f32 v99, v102, v103
    v_cvt_pk_bf16_f32 v100, v104, v105
    v_cvt_pk_bf16_f32 v101, v106, v107
    v_cvt_pk_bf16_f32 v102, v108, v109
    v_cvt_pk_bf16_f32 v103, v110, v111
    v_cndmask_b32 v102, v5, v102, s[60:61]
    v_cndmask_b32 v103, v5, v103, s[60:61]
    buffer_store_dwordx4 v[96:99], v3, s[16:19], s52 offen offset:0 sc1
    buffer_store_dwordx4 v[100:103], v3, s[16:19], s52 offen offset:1024 sc1
    v_cvt_pk_bf16_f32 v112, v112, v113
    v_cvt_pk_bf16_f32 v113, v114, v115
    v_cvt_pk_bf16_f32 v114, v116, v117
    v_cvt_pk_bf16_f32 v115, v118, v119
    v_cvt_pk_bf16_f32 v116, v120, v121
    v_cvt_pk_bf16_f32 v117, v122, v123
    v_cvt_pk_bf16_f32 v118, v124, v125
    v_cvt_pk_bf16_f32 v119, v126, v127
    v_cndmask_b32 v118, v5, v118, s[60:61]
    v_cndmask_b32 v119, v5, v119, s[60:61]
    buffer_store_dwordx4 v[112:115], v3, s[16:19], s52 offen offset:2048 sc1
    buffer_store_dwordx4 v[116:119], v3, s[16:19], s52 offen offset:3072 sc1
    s_add_u32 s52, s51, 8388608
    v_cvt_pk_bf16_f32 v128, v128, v129
    v_cvt_pk_bf16_f32 v129, v130, v131
    v_cvt_pk_bf16_f32 v130, v132, v133
    v_cvt_pk_bf16_f32 v131, v134, v135
    v_cvt_pk_bf16_f32 v132, v136, v137
    v_cvt_pk_bf16_f32 v133, v138, v139
    v_cvt_pk_bf16_f32 v134, v140, v141
    v_cvt_pk_bf16_f32 v135, v142, v143
    v_cndmask_b32 v128, v128, v6, s[62:63]
    v_cndmask_b32 v129, v129, v6, s[62:63]
    v_cndmask_b32 v130, v130, v6, s[62:63]
    v_cndmask_b32 v131, v131, v6, s[62:63]
    v_cndmask_b32 v132, v132, v6, s[62:63]
    v_cndmask_b32 v133, v133, v6, s[62:63]
    v_cndmask_b32 v134, v134, v6, s[62:63]
    v_cndmask_b32 v135, v135, v6, s[62:63]
    buffer_store_dwordx4 v[128:131], v3, s[16:19], s52 offen offset:0 sc1
    buffer_store_dwordx4 v[132:135], v3, s[16:19], s52 offen offset:1024 sc1
    v_cvt_pk_bf16_f32 v144, v144, v145
    v_cvt_pk_bf16_f32 v145, v146, v147
    v_cvt_pk_bf16_f32 v146, v148, v149
    v_cvt_pk_bf16_f32 v147, v150, v151
    v_cvt_pk_bf16_f32 v148, v152, v153
    v_cvt_pk_bf16_f32 v149, v154, v155
    v_cvt_pk_bf16_f32 v150, v156, v157
    v_cvt_pk_bf16_f32 v151, v158, v159
    v_cndmask_b32 v144, v144, v6, s[62:63]
    v_cndmask_b32 v145, v145, v6, s[62:63]
    v_cndmask_b32 v146, v146, v6, s[62:63]
    v_cndmask_b32 v147, v147, v6, s[62:63]
    v_cndmask_b32 v148, v148, v6, s[62:63]
    v_cndmask_b32 v149, v149, v6, s[62:63]
    v_cndmask_b32 v150, v150, v6, s[62:63]
    v_cndmask_b32 v151, v151, v6, s[62:63]
    buffer_store_dwordx4 v[144:147], v3, s[16:19], s52 offen offset:2048 sc1
    buffer_store_dwordx4 v[148:151], v3, s[16:19], s52 offen offset:3072 sc1
K1_END:
    s_endpgm
.p2align 8
.globl attn_kernel
.type attn_kernel,@function
attn_kernel:
    s_cmp_ge_u32 s2, 256
    s_cbranch_scc1 K2_END
    s_load_dwordx2 s[4:5], s[0:1], 72
    s_and_b32 s20, s2, 15
    s_lshr_b32 s21, s2, 4
    v_lshrrev_b32 v1, 6, v0
    v_and_b32 v2, 63, v0
    v_readfirstlane_b32 s22, v1
    s_and_b32 s23, s22, 3
    s_lshr_b32 s24, s22, 2
    s_lshl_b32 s25, s21, 2
    s_add_u32 s25, s25, s23
    v_lshlrev_b32 v3, 4, v2
    s_lshl_b32 s26, s22, 11
    v_add_u32 v4, s26, v3
    s_lshl_b32 s27, s24, 13
    v_add_u32 v5, s27, v3
    v_add_u32 v6, 0x10000, v5
    s_lshl_b32 s28, s20, 17
    s_add_u32 s29, s28, 0x200000
    s_lshl_b32 s30, s25, 11
    v_and_b32 v7, 31, v2
    v_lshlrev_b32 v8, 2, v7
    v_mov_b32 v10, 0
    v_mov_b32 v11, 151552
    ds_write_b32 v11, v10
    s_waitcnt lgkmcnt(0)
    s_mov_b32 s8, s4
    s_and_b32 s9, s5, 0xffff
    s_mov_b32 s10, 18874368
    s_mov_b32 s11, 0x20000
    s_add_u32 s31, s29, s30
    buffer_load_dwordx4 v[16:19], v3, s[8:11], s31 offen
    buffer_load_dwordx4 v[20:23], v3, s[8:11], s31 offen offset:1024
    s_add_u32 s31, s29, s27
    s_add_u32 s31, s31, 4194304
    buffer_load_dwordx4 v[96:99], v3, s[8:11], s31 offen
    buffer_load_dwordx4 v[100:103], v3, s[8:11], s31 offen offset:1024
    s_add_u32 s36, s26, 0
    s_mov_b32 m0, s36
    s_add_u32 s37, s29, 4194304
    buffer_load_dwordx4 v4, s[8:11], s37 offen lds
    buffer_load_dwordx4 v4, s[8:11], s37 offen offset:1024 lds
    s_add_u32 s36, s26, 16384
    s_mov_b32 m0, s36
    s_add_u32 s37, s29, 8388608
    buffer_load_dwordx4 v4, s[8:11], s37 offen lds
    buffer_load_dwordx4 v4, s[8:11], s37 offen offset:1024 lds
    s_lshl_b32 s31, s25, 7
    s_add_u32 s31, s31, 17825792
    buffer_load_dword v9, v8, s[8:11], s31 offen
    s_add_u32 s36, s26, 32768
    s_mov_b32 m0, s36
    s_add_u32 s37, s29, 4210688
    buffer_load_dwordx4 v4, s[8:11], s37 offen lds
    buffer_load_dwordx4 v4, s[8:11], s37 offen offset:1024 lds
    s_add_u32 s36, s26, 49152
    s_mov_b32 m0, s36
    s_add_u32 s37, s29, 8404992
    buffer_load_dwordx4 v4, s[8:11], s37 offen lds
    buffer_load_dwordx4 v4, s[8:11], s37 offen offset:1024 lds
    s_add_u32 s31, s28, s30
    s_sub_u32 s32, s31, 2048
    s_cmp_eq_u32 s25, 0
    s_cselect_b32 s32, s31, s32
    s_cselect_b32 s33, 1000, 32
    s_cmp_eq_u32 s24, 0
    s_cselect_b32 s31, 0x40000000, s31
    s_cselect_b32 s32, 0x40000000, s32
    s_add_u32 s34, s32, 4194304
    s_add_u32 s35, s31, 4194304
    s_add_u32 s44, s32, 8388608
    s_add_u32 s45, s31, 8388608
    s_waitcnt vmcnt(9)
    v_mfma_f32_32x32x16_bf16 v[56:71], v[96:99], v[16:19], 0
    v_mfma_f32_32x32x16_bf16 v[56:71], v[100:103], v[20:23], v[56:71]
    s_nop 11
    v_max3_f32 v12, v56, v57, v58
    v_max3_f32 v12, v12, v59, v60
    v_max3_f32 v12, v12, v61, v62
    v_max3_f32 v12, v12, v63, v64
    v_max3_f32 v12, v12, v65, v66
    v_max3_f32 v12, v12, v67, v68
    v_max3_f32 v12, v12, v69, v70
    v_max_f32 v12, v12, v71
    v_mov_b32 v13, v12
    s_nop 1
    v_permlane32_swap_b32 v12, v13
    v_max_f32 v12, v12, v13
    v_sub_f32 v24, 0, v12
    v_sub_f32 v25, 0, v12
    v_sub_f32 v26, 0, v12
    v_sub_f32 v27, 0, v12
    v_sub_f32 v28, 0, v12
    v_sub_f32 v29, 0, v12
    v_sub_f32 v30, 0, v12
    v_sub_f32 v31, 0, v12
    v_sub_f32 v32, 0, v12
    v_sub_f32 v33, 0, v12
    v_sub_f32 v34, 0, v12
    v_sub_f32 v35, 0, v12
    v_sub_f32 v36, 0, v12
    v_sub_f32 v37, 0, v12
    v_sub_f32 v38, 0, v12
    v_sub_f32 v39, 0, v12
    s_nop 1
    v_mfma_f32_32x32x16_bf16 v[40:55], v[96:99], v[16:19], v[24:39]
    v_mfma_f32_32x32x16_bf16 v[40:55], v[100:103], v[20:23], v[40:55]
    s_waitcnt vmcnt(5)
    s_barrier
    ds_read_b128 v[104:107], v5 offset:2048
    ds_read_b128 v[108:111], v5 offset:3072
    ds_read_b128 v[112:115], v5 offset:16384
    ds_read_b128 v[116:119], v5 offset:17408
    s_waitcnt lgkmcnt(2)
    v_mfma_f32_32x32x16_bf16 v[56:71], v[104:107], v[16:19], v[24:39]
    ds_read_b128 v[96:99], v5 offset:4096
    ds_read_b128 v[100:103], v5 offset:5120
    s_nop 1
    v_exp_f32 v40, v40
    v_exp_f32 v41, v41
    v_exp_f32 v42, v42
    v_exp_f32 v43, v43
    v_cvt_pk_bf16_f32 v72, v40, v41
    v_cvt_pk_bf16_f32 v73, v42, v43
    ds_read_b128 v[120:123], v5 offset:18432
    ds_read_b128 v[124:127], v5 offset:19456
    v_exp_f32 v44, v44
    v_exp_f32 v45, v45
    v_exp_f32 v46, v46
    v_exp_f32 v47, v47
    v_cvt_pk_bf16_f32 v74, v44, v45
    v_cvt_pk_bf16_f32 v75, v46, v47
    v_mfma_f32_32x32x16_bf16 v[56:71], v[108:111], v[20:23], v[56:71]
    s_add_u32 s36, s26, 65536
    s_mov_b32 m0, s36
    s_add_u32 s37, s29, 4227072
    buffer_load_dwordx4 v4, s[8:11], s37 offen lds
    buffer_load_dwordx4 v4, s[8:11], s37 offen offset:1024 lds
    s_add_u32 s36, s26, 81920
    s_mov_b32 m0, s36
    s_add_u32 s37, s29, 8421376
    buffer_load_dwordx4 v4, s[8:11], s37 offen lds
    buffer_load_dwordx4 v4, s[8:11], s37 offen offset:1024 lds
    v_exp_f32 v48, v48
    v_exp_f32 v49, v49
    v_exp_f32 v50, v50
    v_exp_f32 v51, v51
    v_cvt_pk_bf16_f32 v76, v48, v49
    v_cvt_pk_bf16_f32 v77, v50, v51
    s_waitcnt lgkmcnt(4)
    v_mfma_f32_32x32x16_bf16 v[80:95], v[112:115], v[72:75], 0
    v_exp_f32 v52, v52
    v_exp_f32 v53, v53
    v_exp_f32 v54, v54
    v_exp_f32 v55, v55
    v_cvt_pk_bf16_f32 v78, v52, v53
    v_cvt_pk_bf16_f32 v79, v54, v55
    s_waitcnt lgkmcnt(2)
    v_mfma_f32_32x32x16_bf16 v[40:55], v[96:99], v[16:19], v[24:39]
    ds_read_b128 v[104:107], v5 offset:6144
    ds_read_b128 v[108:111], v5 offset:7168
    v_exp_f32 v56, v56
    v_exp_f32 v57, v57
    v_exp_f32 v58, v58
    v_exp_f32 v59, v59
    v_cvt_pk_bf16_f32 v72, v56, v57
    v_cvt_pk_bf16_f32 v73, v58, v59
    v_mfma_f32_32x32x16_bf16 v[80:95], v[116:119], v[76:79], v[80:95]
    ds_read_b128 v[112:115], v5 offset:20480
    ds_read_b128 v[116:119], v5 offset:21504
    v_exp_f32 v60, v60
    v_exp_f32 v61, v61
    v_exp_f32 v62, v62
    v_exp_f32 v63, v63
    v_cvt_pk_bf16_f32 v74, v60, v61
    v_cvt_pk_bf16_f32 v75, v62, v63
    v_mfma_f32_32x32x16_bf16 v[40:55], v[100:103], v[20:23], v[40:55]
    s_add_u32 s36, s26, 98304
    s_mov_b32 m0, s36
    s_add_u32 s37, s29, 4243456
    buffer_load_dwordx4 v4, s[8:11], s37 offen lds
    buffer_load_dwordx4 v4, s[8:11], s37 offen offset:1024 lds
    s_add_u32 s36, s26, 114688
    s_mov_b32 m0, s36
    s_add_u32 s37, s29, 8437760
    buffer_load_dwordx4 v4, s[8:11], s37 offen lds
    buffer_load_dwordx4 v4, s[8:11], s37 offen offset:1024 lds
    v_exp_f32 v64, v64
    v_exp_f32 v65, v65
    v_exp_f32 v66, v66
    v_exp_f32 v67, v67
    v_cvt_pk_bf16_f32 v76, v64, v65
    v_cvt_pk_bf16_f32 v77, v66, v67
    s_waitcnt lgkmcnt(4)
    v_mfma_f32_32x32x16_bf16 v[80:95], v[120:123], v[72:75], v[80:95]
    v_exp_f32 v68, v68
    v_exp_f32 v69, v69
    v_exp_f32 v70, v70
    v_exp_f32 v71, v71
    v_cvt_pk_bf16_f32 v78, v68, v69
    v_cvt_pk_bf16_f32 v79, v70, v71
    s_waitcnt lgkmcnt(2)
    v_mfma_f32_32x32x16_bf16 v[56:71], v[104:107], v[16:19], v[24:39]
    s_waitcnt vmcnt(8)
    s_barrier
    ds_read_b128 v[96:99], v5 offset:32768
    ds_read_b128 v[100:103], v5 offset:33792
    v_exp_f32 v40, v40
    v_exp_f32 v41, v41
    v_exp_f32 v42, v42
    v_exp_f32 v43, v43
    v_cvt_pk_bf16_f32 v72, v40, v41
    v_cvt_pk_bf16_f32 v73, v42, v43
    v_mfma_f32_32x32x16_bf16 v[80:95], v[124:127], v[76:79], v[80:95]
    ds_read_b128 v[120:123], v5 offset:22528
    ds_read_b128 v[124:127], v5 offset:23552
    v_exp_f32 v44, v44
    v_exp_f32 v45, v45
    v_exp_f32 v46, v46
    v_exp_f32 v47, v47
    v_cvt_pk_bf16_f32 v74, v44, v45
    v_cvt_pk_bf16_f32 v75, v46, v47
    v_mfma_f32_32x32x16_bf16 v[56:71], v[108:111], v[20:23], v[56:71]
    buffer_load_dwordx4 v[128:131], v3, s[8:11], s31 offen
    buffer_load_dwordx4 v[132:135], v3, s[8:11], s31 offen offset:1024
    buffer_load_dwordx4 v[136:139], v3, s[8:11], s34 offen
    buffer_load_dwordx4 v[140:143], v3, s[8:11], s34 offen offset:1024
    v_exp_f32 v48, v48
    v_exp_f32 v49, v49
    v_exp_f32 v50, v50
    v_exp_f32 v51, v51
    v_cvt_pk_bf16_f32 v76, v48, v49
    v_cvt_pk_bf16_f32 v77, v50, v51
    s_waitcnt lgkmcnt(4)
    v_mfma_f32_32x32x16_bf16 v[80:95], v[112:115], v[72:75], v[80:95]
    v_exp_f32 v52, v52
    v_exp_f32 v53, v53
    v_exp_f32 v54, v54
    v_exp_f32 v55, v55
    v_cvt_pk_bf16_f32 v78, v52, v53
    v_cvt_pk_bf16_f32 v79, v54, v55
    s_waitcnt lgkmcnt(2)
    v_mfma_f32_32x32x16_bf16 v[40:55], v[96:99], v[16:19], v[24:39]
    ds_read_b128 v[104:107], v5 offset:34816
    ds_read_b128 v[108:111], v5 offset:35840
    v_exp_f32 v56, v56
    v_exp_f32 v57, v57
    v_exp_f32 v58, v58
    v_exp_f32 v59, v59
    v_cvt_pk_bf16_f32 v72, v56, v57
    v_cvt_pk_bf16_f32 v73, v58, v59
    v_mfma_f32_32x32x16_bf16 v[80:95], v[116:119], v[76:79], v[80:95]
    ds_read_b128 v[112:115], v5 offset:49152
    ds_read_b128 v[116:119], v5 offset:50176
    v_exp_f32 v60, v60
    v_exp_f32 v61, v61
    v_exp_f32 v62, v62
    v_exp_f32 v63, v63
    v_cvt_pk_bf16_f32 v74, v60, v61
    v_cvt_pk_bf16_f32 v75, v62, v63
    v_mfma_f32_32x32x16_bf16 v[40:55], v[100:103], v[20:23], v[40:55]
    buffer_load_dwordx4 v[144:147], v3, s[8:11], s35 offen
    buffer_load_dwordx4 v[148:151], v3, s[8:11], s35 offen offset:1024
    buffer_load_dwordx4 v[152:155], v3, s[8:11], s44 offen
    v_exp_f32 v64, v64
    v_exp_f32 v65, v65
    v_exp_f32 v66, v66
    v_exp_f32 v67, v67
    v_cvt_pk_bf16_f32 v76, v64, v65
    v_cvt_pk_bf16_f32 v77, v66, v67
    s_waitcnt lgkmcnt(4)
    v_mfma_f32_32x32x16_bf16 v[80:95], v[120:123], v[72:75], v[80:95]
    v_exp_f32 v68, v68
    v_exp_f32 v69, v69
    v_exp_f32 v70, v70
    v_exp_f32 v71, v71
    v_cvt_pk_bf16_f32 v78, v68, v69
    v_cvt_pk_bf16_f32 v79, v70, v71
    s_waitcnt lgkmcnt(2)
    v_mfma_f32_32x32x16_bf16 v[56:71], v[104:107], v[16:19], v[24:39]
    ds_read_b128 v[96:99], v5 offset:36864
    ds_read_b128 v[100:103], v5 offset:37888
    v_exp_f32 v40, v40
    v_exp_f32 v41, v41
    v_exp_f32 v42, v42
    v_exp_f32 v43, v43
    v_cvt_pk_bf16_f32 v72, v40, v41
    v_cvt_pk_bf16_f32 v73, v42, v43
    v_mfma_f32_32x32x16_bf16 v[80:95], v[124:127], v[76:79], v[80:95]
    ds_read_b128 v[120:123], v5 offset:51200
    ds_read_b128 v[124:127], v5 offset:52224
    v_exp_f32 v44, v44
    v_exp_f32 v45, v45
    v_exp_f32 v46, v46
    v_exp_f32 v47, v47
    v_cvt_pk_bf16_f32 v74, v44, v45
    v_cvt_pk_bf16_f32 v75, v46, v47
    v_mfma_f32_32x32x16_bf16 v[56:71], v[108:111], v[20:23], v[56:71]
    buffer_load_dwordx4 v[156:159], v3, s[8:11], s44 offen offset:1024
    buffer_load_dwordx4 v[160:163], v3, s[8:11], s45 offen
    buffer_load_dwordx4 v[164:167], v3, s[8:11], s45 offen offset:1024
    v_exp_f32 v48, v48
    v_exp_f32 v49, v49
    v_exp_f32 v50, v50
    v_exp_f32 v51, v51
    v_cvt_pk_bf16_f32 v76, v48, v49
    v_cvt_pk_bf16_f32 v77, v50, v51
    s_waitcnt lgkmcnt(4)
    v_mfma_f32_32x32x16_bf16 v[80:95], v[112:115], v[72:75], v[80:95]
    v_exp_f32 v52, v52
    v_exp_f32 v53, v53
    v_exp_f32 v54, v54
    v_exp_f32 v55, v55
    v_cvt_pk_bf16_f32 v78, v52, v53
    v_cvt_pk_bf16_f32 v79, v54, v55
    s_waitcnt lgkmcnt(2)
    v_mfma_f32_32x32x16_bf16 v[40:55], v[96:99], v[16:19], v[24:39]
    ds_read_b128 v[104:107], v5 offset:38912
    ds_read_b128 v[108:111], v5 offset:39936
    v_exp_f32 v56, v56
    v_exp_f32 v57, v57
    v_exp_f32 v58, v58
    v_exp_f32 v59, v59
    v_cvt_pk_bf16_f32 v72, v56, v57
    v_cvt_pk_bf16_f32 v73, v58, v59
    v_mfma_f32_32x32x16_bf16 v[80:95], v[116:119], v[76:79], v[80:95]
    ds_read_b128 v[112:115], v5 offset:53248
    ds_read_b128 v[116:119], v5 offset:54272
    v_exp_f32 v60, v60
    v_exp_f32 v61, v61
    v_exp_f32 v62, v62
    v_exp_f32 v63, v63
    v_cvt_pk_bf16_f32 v74, v60, v61
    v_cvt_pk_bf16_f32 v75, v62, v63
    v_mfma_f32_32x32x16_bf16 v[40:55], v[100:103], v[20:23], v[40:55]
    v_exp_f32 v64, v64
    v_exp_f32 v65, v65
    v_exp_f32 v66, v66
    v_exp_f32 v67, v67
    v_cvt_pk_bf16_f32 v76, v64, v65
    v_cvt_pk_bf16_f32 v77, v66, v67
    s_waitcnt lgkmcnt(4)
    v_mfma_f32_32x32x16_bf16 v[80:95], v[120:123], v[72:75], v[80:95]
    v_exp_f32 v68, v68
    v_exp_f32 v69, v69
    v_exp_f32 v70, v70
    v_exp_f32 v71, v71
    v_cvt_pk_bf16_f32 v78, v68, v69
    v_cvt_pk_bf16_f32 v79, v70, v71
    s_waitcnt lgkmcnt(2)
    v_mfma_f32_32x32x16_bf16 v[56:71], v[104:107], v[16:19], v[24:39]
    s_waitcnt vmcnt(14)
    s_barrier
    s_add_u32 s36, s26, 0
    s_mov_b32 m0, s36
    s_add_u32 s37, s29, 4259840
    buffer_load_dwordx4 v4, s[8:11], s37 offen lds
    buffer_load_dwordx4 v4, s[8:11], s37 offen offset:1024 lds
    s_add_u32 s36, s26, 16384
    s_mov_b32 m0, s36
    s_add_u32 s37, s29, 8454144
    buffer_load_dwordx4 v4, s[8:11], s37 offen lds
    buffer_load_dwordx4 v4, s[8:11], s37 offen offset:1024 lds
    ds_read_b128 v[96:99], v6 offset:0
    ds_read_b128 v[100:103], v6 offset:1024
    v_exp_f32 v40, v40
    v_exp_f32 v41, v41
    v_exp_f32 v42, v42
    v_exp_f32 v43, v43
    v_cvt_pk_bf16_f32 v72, v40, v41
    v_cvt_pk_bf16_f32 v73, v42, v43
    v_mfma_f32_32x32x16_bf16 v[80:95], v[124:127], v[76:79], v[80:95]
    ds_read_b128 v[120:123], v5 offset:55296
    ds_read_b128 v[124:127], v5 offset:56320
    v_exp_f32 v44, v44
    v_exp_f32 v45, v45
    v_exp_f32 v46, v46
    v_exp_f32 v47, v47
    v_cvt_pk_bf16_f32 v74, v44, v45
    v_cvt_pk_bf16_f32 v75, v46, v47
    v_mfma_f32_32x32x16_bf16 v[56:71], v[108:111], v[20:23], v[56:71]
    v_exp_f32 v48, v48
    v_exp_f32 v49, v49
    v_exp_f32 v50, v50
    v_exp_f32 v51, v51
    v_cvt_pk_bf16_f32 v76, v48, v49
    v_cvt_pk_bf16_f32 v77, v50, v51
    s_waitcnt lgkmcnt(4)
    v_mfma_f32_32x32x16_bf16 v[80:95], v[112:115], v[72:75], v[80:95]
    v_exp_f32 v52, v52
    v_exp_f32 v53, v53
    v_exp_f32 v54, v54
    v_exp_f32 v55, v55
    v_cvt_pk_bf16_f32 v78, v52, v53
    v_cvt_pk_bf16_f32 v79, v54, v55
    s_waitcnt lgkmcnt(2)
    v_mfma_f32_32x32x16_bf16 v[40:55], v[96:99], v[16:19], v[24:39]
    ds_read_b128 v[104:107], v6 offset:2048
    ds_read_b128 v[108:111], v6 offset:3072
    v_exp_f32 v56, v56
    v_exp_f32 v57, v57
    v_exp_f32 v58, v58
    v_exp_f32 v59, v59
    v_cvt_pk_bf16_f32 v72, v56, v57
    v_cvt_pk_bf16_f32 v73, v58, v59
    v_mfma_f32_32x32x16_bf16 v[80:95], v[116:119], v[76:79], v[80:95]
    ds_read_b128 v[112:115], v6 offset:16384
    ds_read_b128 v[116:119], v6 offset:17408
    v_exp_f32 v60, v60
    v_exp_f32 v61, v61
    v_exp_f32 v62, v62
    v_exp_f32 v63, v63
    v_cvt_pk_bf16_f32 v74, v60, v61
    v_cvt_pk_bf16_f32 v75, v62, v63
    v_mfma_f32_32x32x16_bf16 v[40:55], v[100:103], v[20:23], v[40:55]
    v_exp_f32 v64, v64
    v_exp_f32 v65, v65
    v_exp_f32 v66, v66
    v_exp_f32 v67, v67
    v_cvt_pk_bf16_f32 v76, v64, v65
    v_cvt_pk_bf16_f32 v77, v66, v67
    s_waitcnt lgkmcnt(4)
    v_mfma_f32_32x32x16_bf16 v[80:95], v[120:123], v[72:75], v[80:95]
    v_exp_f32 v68, v68
    v_exp_f32 v69, v69
    v_exp_f32 v70, v70
    v_exp_f32 v71, v71
    v_cvt_pk_bf16_f32 v78, v68, v69
    v_cvt_pk_bf16_f32 v79, v70, v71
    s_waitcnt lgkmcnt(2)
    v_mfma_f32_32x32x16_bf16 v[56:71], v[104:107], v[16:19], v[24:39]
    ds_read_b128 v[96:99], v6 offset:4096
    ds_read_b128 v[100:103], v6 offset:5120
    v_exp_f32 v40, v40
    v_exp_f32 v41, v41
    v_exp_f32 v42, v42
    v_exp_f32 v43, v43
    v_cvt_pk_bf16_f32 v72, v40, v41
    v_cvt_pk_bf16_f32 v73, v42, v43
    v_mfma_f32_32x32x16_bf16 v[80:95], v[124:127], v[76:79], v[80:95]
    ds_read_b128 v[120:123], v6 offset:18432
    ds_read_b128 v[124:127], v6 offset:19456
    v_exp_f32 v44, v44
    v_exp_f32 v45, v45
    v_exp_f32 v46, v46
    v_exp_f32 v47, v47
    v_cvt_pk_bf16_f32 v74, v44, v45
    v_cvt_pk_bf16_f32 v75, v46, v47
    v_mfma_f32_32x32x16_bf16 v[56:71], v[108:111], v[20:23], v[56:71]
    v_exp_f32 v48, v48
    v_exp_f32 v49, v49
    v_exp_f32 v50, v50
    v_exp_f32 v51, v51
    v_cvt_pk_bf16_f32 v76, v48, v49
    v_cvt_pk_bf16_f32 v77, v50, v51
    s_waitcnt lgkmcnt(4)
    v_mfma_f32_32x32x16_bf16 v[80:95], v[112:115], v[72:75], v[80:95]
    v_exp_f32 v52, v52
    v_exp_f32 v53, v53
    v_exp_f32 v54, v54
    v_exp_f32 v55, v55
    v_cvt_pk_bf16_f32 v78, v52, v53
    v_cvt_pk_bf16_f32 v79, v54, v55
    s_waitcnt lgkmcnt(2)
    v_mfma_f32_32x32x16_bf16 v[40:55], v[96:99], v[16:19], v[24:39]
    ds_read_b128 v[104:107], v6 offset:6144
    ds_read_b128 v[108:111], v6 offset:7168
    v_exp_f32 v56, v56
    v_exp_f32 v57, v57
    v_exp_f32 v58, v58
    v_exp_f32 v59, v59
    v_cvt_pk_bf16_f32 v72, v56, v57
    v_cvt_pk_bf16_f32 v73, v58, v59
    v_mfma_f32_32x32x16_bf16 v[80:95], v[116:119], v[76:79], v[80:95]
    ds_read_b128 v[112:115], v6 offset:20480
    ds_read_b128 v[116:119], v6 offset:21504
    v_exp_f32 v60, v60
    v_exp_f32 v61, v61
    v_exp_f32 v62, v62
    v_exp_f32 v63, v63
    v_cvt_pk_bf16_f32 v74, v60, v61
    v_cvt_pk_bf16_f32 v75, v62, v63
    v_mfma_f32_32x32x16_bf16 v[40:55], v[100:103], v[20:23], v[40:55]
    v_exp_f32 v64, v64
    v_exp_f32 v65, v65
    v_exp_f32 v66, v66
    v_exp_f32 v67, v67
    v_cvt_pk_bf16_f32 v76, v64, v65
    v_cvt_pk_bf16_f32 v77, v66, v67
    s_waitcnt lgkmcnt(4)
    v_mfma_f32_32x32x16_bf16 v[80:95], v[120:123], v[72:75], v[80:95]
    v_exp_f32 v68, v68
    v_exp_f32 v69, v69
    v_exp_f32 v70, v70
    v_exp_f32 v71, v71
    v_cvt_pk_bf16_f32 v78, v68, v69
    v_cvt_pk_bf16_f32 v79, v70, v71
    s_waitcnt lgkmcnt(2)
    v_mfma_f32_32x32x16_bf16 v[56:71], v[104:107], v[16:19], v[24:39]
    s_waitcnt vmcnt(14)
    s_barrier
    s_add_u32 s36, s26, 32768
    s_mov_b32 m0, s36
    s_add_u32 s37, s29, 4276224
    buffer_load_dwordx4 v4, s[8:11], s37 offen lds
    buffer_load_dwordx4 v4, s[8:11], s37 offen offset:1024 lds
    s_add_u32 s36, s26, 49152
    s_mov_b32 m0, s36
    s_add_u32 s37, s29, 8470528
    buffer_load_dwordx4 v4, s[8:11], s37 offen lds
    buffer_load_dwordx4 v4, s[8:11], s37 offen offset:1024 lds
    ds_read_b128 v[96:99], v6 offset:32768
    ds_read_b128 v[100:103], v6 offset:33792
    v_exp_f32 v40, v40
    v_exp_f32 v41, v41
    v_exp_f32 v42, v42
    v_exp_f32 v43, v43
    v_cvt_pk_bf16_f32 v72, v40, v41
    v_cvt_pk_bf16_f32 v73, v42, v43
    v_mfma_f32_32x32x16_bf16 v[80:95], v[124:127], v[76:79], v[80:95]
    ds_read_b128 v[120:123], v6 offset:22528
    ds_read_b128 v[124:127], v6 offset:23552
    v_exp_f32 v44, v44
    v_exp_f32 v45, v45
    v_exp_f32 v46, v46
    v_exp_f32 v47, v47
    v_cvt_pk_bf16_f32 v74, v44, v45
    v_cvt_pk_bf16_f32 v75, v46, v47
    v_mfma_f32_32x32x16_bf16 v[56:71], v[108:111], v[20:23], v[56:71]
    v_exp_f32 v48, v48
    v_exp_f32 v49, v49
    v_exp_f32 v50, v50
    v_exp_f32 v51, v51
    v_cvt_pk_bf16_f32 v76, v48, v49
    v_cvt_pk_bf16_f32 v77, v50, v51
    s_waitcnt lgkmcnt(4)
    v_mfma_f32_32x32x16_bf16 v[80:95], v[112:115], v[72:75], v[80:95]
    v_exp_f32 v52, v52
    v_exp_f32 v53, v53
    v_exp_f32 v54, v54
    v_exp_f32 v55, v55
    v_cvt_pk_bf16_f32 v78, v52, v53
    v_cvt_pk_bf16_f32 v79, v54, v55
    s_waitcnt lgkmcnt(2)
    v_mfma_f32_32x32x16_bf16 v[40:55], v[96:99], v[16:19], v[24:39]
    ds_read_b128 v[104:107], v6 offset:34816
    ds_read_b128 v[108:111], v6 offset:35840
    v_exp_f32 v56, v56
    v_exp_f32 v57, v57
    v_exp_f32 v58, v58
    v_exp_f32 v59, v59
    v_cvt_pk_bf16_f32 v72, v56, v57
    v_cvt_pk_bf16_f32 v73, v58, v59
    v_mfma_f32_32x32x16_bf16 v[80:95], v[116:119], v[76:79], v[80:95]
    ds_read_b128 v[112:115], v6 offset:49152
    ds_read_b128 v[116:119], v6 offset:50176
    v_exp_f32 v60, v60
    v_exp_f32 v61, v61
    v_exp_f32 v62, v62
    v_exp_f32 v63, v63
    v_cvt_pk_bf16_f32 v74, v60, v61
    v_cvt_pk_bf16_f32 v75, v62, v63
    v_mfma_f32_32x32x16_bf16 v[40:55], v[100:103], v[20:23], v[40:55]
    v_exp_f32 v64, v64
    v_exp_f32 v65, v65
    v_exp_f32 v66, v66
    v_exp_f32 v67, v67
    v_cvt_pk_bf16_f32 v76, v64, v65
    v_cvt_pk_bf16_f32 v77, v66, v67
    s_waitcnt lgkmcnt(4)
    v_mfma_f32_32x32x16_bf16 v[80:95], v[120:123], v[72:75], v[80:95]
    v_exp_f32 v68, v68
    v_exp_f32 v69, v69
    v_exp_f32 v70, v70
    v_exp_f32 v71, v71
    v_cvt_pk_bf16_f32 v78, v68, v69
    v_cvt_pk_bf16_f32 v79, v70, v71
    s_waitcnt lgkmcnt(2)
    v_mfma_f32_32x32x16_bf16 v[56:71], v[104:107], v[16:19], v[24:39]
    ds_read_b128 v[96:99], v6 offset:36864
    ds_read_b128 v[100:103], v6 offset:37888
    v_exp_f32 v40, v40
    v_exp_f32 v41, v41
    v_exp_f32 v42, v42
    v_exp_f32 v43, v43
    v_cvt_pk_bf16_f32 v72, v40, v41
    v_cvt_pk_bf16_f32 v73, v42, v43
    v_mfma_f32_32x32x16_bf16 v[80:95], v[124:127], v[76:79], v[80:95]
    ds_read_b128 v[120:123], v6 offset:51200
    ds_read_b128 v[124:127], v6 offset:52224
    v_exp_f32 v44, v44
    v_exp_f32 v45, v45
    v_exp_f32 v46, v46
    v_exp_f32 v47, v47
    v_cvt_pk_bf16_f32 v74, v44, v45
    v_cvt_pk_bf16_f32 v75, v46, v47
    v_mfma_f32_32x32x16_bf16 v[56:71], v[108:111], v[20:23], v[56:71]
    v_exp_f32 v48, v48
    v_exp_f32 v49, v49
    v_exp_f32 v50, v50
    v_exp_f32 v51, v51
    v_cvt_pk_bf16_f32 v76, v48, v49
    v_cvt_pk_bf16_f32 v77, v50, v51
    s_waitcnt lgkmcnt(4)
    v_mfma_f32_32x32x16_bf16 v[80:95], v[112:115], v[72:75], v[80:95]
    v_exp_f32 v52, v52
    v_exp_f32 v53, v53
    v_exp_f32 v54, v54
    v_exp_f32 v55, v55
    v_cvt_pk_bf16_f32 v78, v52, v53
    v_cvt_pk_bf16_f32 v79, v54, v55
    s_waitcnt lgkmcnt(2)
    v_mfma_f32_32x32x16_bf16 v[40:55], v[96:99], v[16:19], v[24:39]
    ds_read_b128 v[104:107], v6 offset:38912
    ds_read_b128 v[108:111], v6 offset:39936
    v_exp_f32 v56, v56
    v_exp_f32 v57, v57
    v_exp_f32 v58, v58
    v_exp_f32 v59, v59
    v_cvt_pk_bf16_f32 v72, v56, v57
    v_cvt_pk_bf16_f32 v73, v58, v59
    v_mfma_f32_32x32x16_bf16 v[80:95], v[116:119], v[76:79], v[80:95]
    ds_read_b128 v[112:115], v6 offset:53248
    ds_read_b128 v[116:119], v6 offset:54272
    v_exp_f32 v60, v60
    v_exp_f32 v61, v61
    v_exp_f32 v62, v62
    v_exp_f32 v63, v63
    v_cvt_pk_bf16_f32 v74, v60, v61
    v_cvt_pk_bf16_f32 v75, v62, v63
    v_mfma_f32_32x32x16_bf16 v[40:55], v[100:103], v[20:23], v[40:55]
    v_exp_f32 v64, v64
    v_exp_f32 v65, v65
    v_exp_f32 v66, v66
    v_exp_f32 v67, v67
    v_cvt_pk_bf16_f32 v76, v64, v65
    v_cvt_pk_bf16_f32 v77, v66, v67
    s_waitcnt lgkmcnt(4)
    v_mfma_f32_32x32x16_bf16 v[80:95], v[120:123], v[72:75], v[80:95]
    v_exp_f32 v68, v68
    v_exp_f32 v69, v69
    v_exp_f32 v70, v70
    v_exp_f32 v71, v71
    v_cvt_pk_bf16_f32 v78, v68, v69
    v_cvt_pk_bf16_f32 v79, v70, v71
    s_waitcnt lgkmcnt(2)
    v_mfma_f32_32x32x16_bf16 v[56:71], v[104:107], v[16:19], v[24:39]
    s_waitcnt vmcnt(4)
    s_barrier
    s_add_u32 s36, s26, 65536
    s_mov_b32 m0, s36
    s_add_u32 s37, s29, 4292608
    buffer_load_dwordx4 v4, s[8:11], s37 offen lds
    buffer_load_dwordx4 v4, s[8:11], s37 offen offset:1024 lds
    s_add_u32 s36, s26, 81920
    s_mov_b32 m0, s36
    s_add_u32 s37, s29, 8486912
    buffer_load_dwordx4 v4, s[8:11], s37 offen lds
    buffer_load_dwordx4 v4, s[8:11], s37 offen offset:1024 lds
    ds_read_b128 v[96:99], v5 offset:0
    ds_read_b128 v[100:103], v5 offset:1024
    v_exp_f32 v40, v40
    v_exp_f32 v41, v41
    v_exp_f32 v42, v42
    v_exp_f32 v43, v43
    v_cvt_pk_bf16_f32 v72, v40, v41
    v_cvt_pk_bf16_f32 v73, v42, v43
    v_mfma_f32_32x32x16_bf16 v[80:95], v[124:127], v[76:79], v[80:95]
    ds_read_b128 v[120:123], v6 offset:55296
    ds_read_b128 v[124:127], v6 offset:56320
    v_exp_f32 v44, v44
    v_exp_f32 v45, v45
    v_exp_f32 v46, v46
    v_exp_f32 v47, v47
    v_cvt_pk_bf16_f32 v74, v44, v45
    v_cvt_pk_bf16_f32 v75, v46, v47
    v_mfma_f32_32x32x16_bf16 v[56:71], v[108:111], v[20:23], v[56:71]
    v_exp_f32 v48, v48
    v_exp_f32 v49, v49
    v_exp_f32 v50, v50
    v_exp_f32 v51, v51
    v_cvt_pk_bf16_f32 v76, v48, v49
    v_cvt_pk_bf16_f32 v77, v50, v51
    s_waitcnt lgkmcnt(4)
    v_mfma_f32_32x32x16_bf16 v[80:95], v[112:115], v[72:75], v[80:95]
    v_exp_f32 v52, v52
    v_exp_f32 v53, v53
    v_exp_f32 v54, v54
    v_exp_f32 v55, v55
    v_cvt_pk_bf16_f32 v78, v52, v53
    v_cvt_pk_bf16_f32 v79, v54, v55
    s_waitcnt lgkmcnt(2)
    v_mfma_f32_32x32x16_bf16 v[40:55], v[96:99], v[16:19], v[24:39]
    ds_read_b128 v[104:107], v5 offset:2048
    ds_read_b128 v[108:111], v5 offset:3072
    v_exp_f32 v56, v56
    v_exp_f32 v57, v57
    v_exp_f32 v58, v58
    v_exp_f32 v59, v59
    v_cvt_pk_bf16_f32 v72, v56, v57
    v_cvt_pk_bf16_f32 v73, v58, v59
    v_mfma_f32_32x32x16_bf16 v[80:95], v[116:119], v[76:79], v[80:95]
    ds_read_b128 v[112:115], v5 offset:16384
    ds_read_b128 v[116:119], v5 offset:17408
    v_exp_f32 v60, v60
    v_exp_f32 v61, v61
    v_exp_f32 v62, v62
    v_exp_f32 v63, v63
    v_cvt_pk_bf16_f32 v74, v60, v61
    v_cvt_pk_bf16_f32 v75, v62, v63
    v_mfma_f32_32x32x16_bf16 v[40:55], v[100:103], v[20:23], v[40:55]
    v_exp_f32 v64, v64
    v_exp_f32 v65, v65
    v_exp_f32 v66, v66
    v_exp_f32 v67, v67
    v_cvt_pk_bf16_f32 v76, v64, v65
    v_cvt_pk_bf16_f32 v77, v66, v67
    s_waitcnt lgkmcnt(4)
    v_mfma_f32_32x32x16_bf16 v[80:95], v[120:123], v[72:75], v[80:95]
    v_exp_f32 v68, v68
    v_exp_f32 v69, v69
    v_exp_f32 v70, v70
    v_exp_f32 v71, v71
    v_cvt_pk_bf16_f32 v78, v68, v69
    v_cvt_pk_bf16_f32 v79, v70, v71
    s_waitcnt lgkmcnt(2)
    v_mfma_f32_32x32x16_bf16 v[56:71], v[104:107], v[16:19], v[24:39]
    ds_read_b128 v[96:99], v5 offset:4096
    ds_read_b128 v[100:103], v5 offset:5120
    v_exp_f32 v40, v40
    v_exp_f32 v41, v41
    v_exp_f32 v42, v42
    v_exp_f32 v43, v43
    v_cvt_pk_bf16_f32 v72, v40, v41
    v_cvt_pk_bf16_f32 v73, v42, v43
    v_mfma_f32_32x32x16_bf16 v[80:95], v[124:127], v[76:79], v[80:95]
    ds_read_b128 v[120:123], v5 offset:18432
    ds_read_b128 v[124:127], v5 offset:19456
    v_exp_f32 v44, v44
    v_exp_f32 v45, v45
    v_exp_f32 v46, v46
    v_exp_f32 v47, v47
    v_cvt_pk_bf16_f32 v74, v44, v45
    v_cvt_pk_bf16_f32 v75, v46, v47
    v_mfma_f32_32x32x16_bf16 v[56:71], v[108:111], v[20:23], v[56:71]
    v_exp_f32 v48, v48
    v_exp_f32 v49, v49
    v_exp_f32 v50, v50
    v_exp_f32 v51, v51
    v_cvt_pk_bf16_f32 v76, v48, v49
    v_cvt_pk_bf16_f32 v77, v50, v51
    s_waitcnt lgkmcnt(4)
    v_mfma_f32_32x32x16_bf16 v[80:95], v[112:115], v[72:75], v[80:95]
    v_exp_f32 v52, v52
    v_exp_f32 v53, v53
    v_exp_f32 v54, v54
    v_exp_f32 v55, v55
    v_cvt_pk_bf16_f32 v78, v52, v53
    v_cvt_pk_bf16_f32 v79, v54, v55
    s_waitcnt lgkmcnt(2)
    v_mfma_f32_32x32x16_bf16 v[40:55], v[96:99], v[16:19], v[24:39]
    ds_read_b128 v[104:107], v5 offset:6144
    ds_read_b128 v[108:111], v5 offset:7168
    v_exp_f32 v56, v56
    v_exp_f32 v57, v57
    v_exp_f32 v58, v58
    v_exp_f32 v59, v59
    v_cvt_pk_bf16_f32 v72, v56, v57
    v_cvt_pk_bf16_f32 v73, v58, v59
    v_mfma_f32_32x32x16_bf16 v[80:95], v[116:119], v[76:79], v[80:95]
    ds_read_b128 v[112:115], v5 offset:20480
    ds_read_b128 v[116:119], v5 offset:21504
    v_exp_f32 v60, v60
    v_exp_f32 v61, v61
    v_exp_f32 v62, v62
    v_exp_f32 v63, v63
    v_cvt_pk_bf16_f32 v74, v60, v61
    v_cvt_pk_bf16_f32 v75, v62, v63
    v_mfma_f32_32x32x16_bf16 v[40:55], v[100:103], v[20:23], v[40:55]
    v_exp_f32 v64, v64
    v_exp_f32 v65, v65
    v_exp_f32 v66, v66
    v_exp_f32 v67, v67
    v_cvt_pk_bf16_f32 v76, v64, v65
    v_cvt_pk_bf16_f32 v77, v66, v67
    s_waitcnt lgkmcnt(4)
    v_mfma_f32_32x32x16_bf16 v[80:95], v[120:123], v[72:75], v[80:95]
    v_exp_f32 v68, v68
    v_exp_f32 v69, v69
    v_exp_f32 v70, v70
    v_exp_f32 v71, v71
    v_cvt_pk_bf16_f32 v78, v68, v69
    v_cvt_pk_bf16_f32 v79, v70, v71
    s_waitcnt lgkmcnt(2)
    v_mfma_f32_32x32x16_bf16 v[56:71], v[104:107], v[16:19], v[24:39]
    s_waitcnt vmcnt(4)
    s_barrier
    s_add_u32 s36, s26, 98304
    s_mov_b32 m0, s36
    s_add_u32 s37, s29, 4308992
    buffer_load_dwordx4 v4, s[8:11], s37 offen lds
    buffer_load_dwordx4 v4, s[8:11], s37 offen offset:1024 lds
    s_add_u32 s36, s26, 114688
    s_mov_b32 m0, s36
    s_add_u32 s37, s29, 8503296
    buffer_load_dwordx4 v4, s[8:11], s37 offen lds
    buffer_load_dwordx4 v4, s[8:11], s37 offen offset:1024 lds
    ds_read_b128 v[96:99], v5 offset:32768
    ds_read_b128 v[100:103], v5 offset:33792
    v_exp_f32 v40, v40
    v_exp_f32 v41, v41
    v_exp_f32 v42, v42
    v_exp_f32 v43, v43
    v_cvt_pk_bf16_f32 v72, v40, v41
    v_cvt_pk_bf16_f32 v73, v42, v43
    v_mfma_f32_32x32x16_bf16 v[80:95], v[124:127], v[76:79], v[80:95]
    ds_read_b128 v[120:123], v5 offset:22528
    ds_read_b128 v[124:127], v5 offset:23552
    v_exp_f32 v44, v44
    v_exp_f32 v45, v45
    v_exp_f32 v46, v46
    v_exp_f32 v47, v47
    v_cvt_pk_bf16_f32 v74, v44, v45
    v_cvt_pk_bf16_f32 v75, v46, v47
    v_mfma_f32_32x32x16_bf16 v[56:71], v[108:111], v[20:23], v[56:71]
    v_exp_f32 v48, v48
    v_exp_f32 v49, v49
    v_exp_f32 v50, v50
    v_exp_f32 v51, v51
    v_cvt_pk_bf16_f32 v76, v48, v49
    v_cvt_pk_bf16_f32 v77, v50, v51
    s_waitcnt lgkmcnt(4)
    v_mfma_f32_32x32x16_bf16 v[80:95], v[112:115], v[72:75], v[80:95]
    v_exp_f32 v52, v52
    v_exp_f32 v53, v53
    v_exp_f32 v54, v54
    v_exp_f32 v55, v55
    v_cvt_pk_bf16_f32 v78, v52, v53
    v_cvt_pk_bf16_f32 v79, v54, v55
    s_waitcnt lgkmcnt(2)
    v_mfma_f32_32x32x16_bf16 v[40:55], v[96:99], v[16:19], v[24:39]
    ds_read_b128 v[104:107], v5 offset:34816
    ds_read_b128 v[108:111], v5 offset:35840
    v_exp_f32 v56, v56
    v_exp_f32 v57, v57
    v_exp_f32 v58, v58
    v_exp_f32 v59, v59
    v_cvt_pk_bf16_f32 v72, v56, v57
    v_cvt_pk_bf16_f32 v73, v58, v59
    v_mfma_f32_32x32x16_bf16 v[80:95], v[116:119], v[76:79], v[80:95]
    ds_read_b128 v[112:115], v5 offset:49152
    ds_read_b128 v[116:119], v5 offset:50176
    v_exp_f32 v60, v60
    v_exp_f32 v61, v61
    v_exp_f32 v62, v62
    v_exp_f32 v63, v63
    v_cvt_pk_bf16_f32 v74, v60, v61
    v_cvt_pk_bf16_f32 v75, v62, v63
    v_mfma_f32_32x32x16_bf16 v[40:55], v[100:103], v[20:23], v[40:55]
    v_exp_f32 v64, v64
    v_exp_f32 v65, v65
    v_exp_f32 v66, v66
    v_exp_f32 v67, v67
    v_cvt_pk_bf16_f32 v76, v64, v65
    v_cvt_pk_bf16_f32 v77, v66, v67
    s_waitcnt lgkmcnt(4)
    v_mfma_f32_32x32x16_bf16 v[80:95], v[120:123], v[72:75], v[80:95]
    v_exp_f32 v68, v68
    v_exp_f32 v69, v69
    v_exp_f32 v70, v70
    v_exp_f32 v71, v71
    v_cvt_pk_bf16_f32 v78, v68, v69
    v_cvt_pk_bf16_f32 v79, v70, v71
    s_waitcnt lgkmcnt(2)
    v_mfma_f32_32x32x16_bf16 v[56:71], v[104:107], v[16:19], v[24:39]
    ds_read_b128 v[96:99], v5 offset:36864
    ds_read_b128 v[100:103], v5 offset:37888
    v_exp_f32 v40, v40
    v_exp_f32 v41, v41
    v_exp_f32 v42, v42
    v_exp_f32 v43, v43
    v_cvt_pk_bf16_f32 v72, v40, v41
    v_cvt_pk_bf16_f32 v73, v42, v43
    v_mfma_f32_32x32x16_bf16 v[80:95], v[124:127], v[76:79], v[80:95]
    ds_read_b128 v[120:123], v5 offset:51200
    ds_read_b128 v[124:127], v5 offset:52224
    v_exp_f32 v44, v44
    v_exp_f32 v45, v45
    v_exp_f32 v46, v46
    v_exp_f32 v47, v47
    v_cvt_pk_bf16_f32 v74, v44, v45
    v_cvt_pk_bf16_f32 v75, v46, v47
    v_mfma_f32_32x32x16_bf16 v[56:71], v[108:111], v[20:23], v[56:71]
    v_exp_f32 v48, v48
    v_exp_f32 v49, v49
    v_exp_f32 v50, v50
    v_exp_f32 v51, v51
    v_cvt_pk_bf16_f32 v76, v48, v49
    v_cvt_pk_bf16_f32 v77, v50, v51
    s_waitcnt lgkmcnt(4)
    v_mfma_f32_32x32x16_bf16 v[80:95], v[112:115], v[72:75], v[80:95]
    v_exp_f32 v52, v52
    v_exp_f32 v53, v53
    v_exp_f32 v54, v54
    v_exp_f32 v55, v55
    v_cvt_pk_bf16_f32 v78, v52, v53
    v_cvt_pk_bf16_f32 v79, v54, v55
    s_waitcnt lgkmcnt(2)
    v_mfma_f32_32x32x16_bf16 v[40:55], v[96:99], v[16:19], v[24:39]
    ds_read_b128 v[104:107], v5 offset:38912
    ds_read_b128 v[108:111], v5 offset:39936
    v_exp_f32 v56, v56
    v_exp_f32 v57, v57
    v_exp_f32 v58, v58
    v_exp_f32 v59, v59
    v_cvt_pk_bf16_f32 v72, v56, v57
    v_cvt_pk_bf16_f32 v73, v58, v59
    v_mfma_f32_32x32x16_bf16 v[80:95], v[116:119], v[76:79], v[80:95]
    ds_read_b128 v[112:115], v5 offset:53248
    ds_read_b128 v[116:119], v5 offset:54272
    v_exp_f32 v60, v60
    v_exp_f32 v61, v61
    v_exp_f32 v62, v62
    v_exp_f32 v63, v63
    v_cvt_pk_bf16_f32 v74, v60, v61
    v_cvt_pk_bf16_f32 v75, v62, v63
    v_mfma_f32_32x32x16_bf16 v[40:55], v[100:103], v[20:23], v[40:55]
    v_exp_f32 v64, v64
    v_exp_f32 v65, v65
    v_exp_f32 v66, v66
    v_exp_f32 v67, v67
    v_cvt_pk_bf16_f32 v76, v64, v65
    v_cvt_pk_bf16_f32 v77, v66, v67
    s_waitcnt lgkmcnt(4)
    v_mfma_f32_32x32x16_bf16 v[80:95], v[120:123], v[72:75], v[80:95]
    v_exp_f32 v68, v68
    v_exp_f32 v69, v69
    v_exp_f32 v70, v70
    v_exp_f32 v71, v71
    v_cvt_pk_bf16_f32 v78, v68, v69
    v_cvt_pk_bf16_f32 v79, v70, v71
    s_waitcnt lgkmcnt(2)
    v_mfma_f32_32x32x16_bf16 v[56:71], v[104:107], v[16:19], v[24:39]
    s_waitcnt vmcnt(4)
    s_barrier
    ds_read_b128 v[96:99], v6 offset:0
    ds_read_b128 v[100:103], v6 offset:1024
    v_exp_f32 v40, v40
    v_exp_f32 v41, v41
    v_exp_f32 v42, v42
    v_exp_f32 v43, v43
    v_cvt_pk_bf16_f32 v72, v40, v41
    v_cvt_pk_bf16_f32 v73, v42, v43
    v_mfma_f32_32x32x16_bf16 v[80:95], v[124:127], v[76:79], v[80:95]
    ds_read_b128 v[120:123], v5 offset:55296
    ds_read_b128 v[124:127], v5 offset:56320
    v_exp_f32 v44, v44
    v_exp_f32 v45, v45
    v_exp_f32 v46, v46
    v_exp_f32 v47, v47
    v_cvt_pk_bf16_f32 v74, v44, v45
    v_cvt_pk_bf16_f32 v75, v46, v47
    v_mfma_f32_32x32x16_bf16 v[56:71], v[108:111], v[20:23], v[56:71]
    v_exp_f32 v48, v48
    v_exp_f32 v49, v49
    v_exp_f32 v50, v50
    v_exp_f32 v51, v51
    v_cvt_pk_bf16_f32 v76, v48, v49
    v_cvt_pk_bf16_f32 v77, v50, v51
    s_waitcnt lgkmcnt(4)
    v_mfma_f32_32x32x16_bf16 v[80:95], v[112:115], v[72:75], v[80:95]
    v_exp_f32 v52, v52
    v_exp_f32 v53, v53
    v_exp_f32 v54, v54
    v_exp_f32 v55, v55
    v_cvt_pk_bf16_f32 v78, v52, v53
    v_cvt_pk_bf16_f32 v79, v54, v55
    s_waitcnt lgkmcnt(2)
    v_mfma_f32_32x32x16_bf16 v[40:55], v[96:99], v[16:19], v[24:39]
    ds_read_b128 v[104:107], v6 offset:2048
    ds_read_b128 v[108:111], v6 offset:3072
    v_exp_f32 v56, v56
    v_exp_f32 v57, v57
    v_exp_f32 v58, v58
    v_exp_f32 v59, v59
    v_cvt_pk_bf16_f32 v72, v56, v57
    v_cvt_pk_bf16_f32 v73, v58, v59
    v_mfma_f32_32x32x16_bf16 v[80:95], v[116:119], v[76:79], v[80:95]
    ds_read_b128 v[112:115], v6 offset:16384
    ds_read_b128 v[116:119], v6 offset:17408
    v_exp_f32 v60, v60
    v_exp_f32 v61, v61
    v_exp_f32 v62, v62
    v_exp_f32 v63, v63
    v_cvt_pk_bf16_f32 v74, v60, v61
    v_cvt_pk_bf16_f32 v75, v62, v63
    v_mfma_f32_32x32x16_bf16 v[40:55], v[100:103], v[20:23], v[40:55]
    v_exp_f32 v64, v64
    v_exp_f32 v65, v65
    v_exp_f32 v66, v66
    v_exp_f32 v67, v67
    v_cvt_pk_bf16_f32 v76, v64, v65
    v_cvt_pk_bf16_f32 v77, v66, v67
    s_waitcnt lgkmcnt(4)
    v_mfma_f32_32x32x16_bf16 v[80:95], v[120:123], v[72:75], v[80:95]
    v_exp_f32 v68, v68
    v_exp_f32 v69, v69
    v_exp_f32 v70, v70
    v_exp_f32 v71, v71
    v_cvt_pk_bf16_f32 v78, v68, v69
    v_cvt_pk_bf16_f32 v79, v70, v71
    s_waitcnt lgkmcnt(2)
    v_mfma_f32_32x32x16_bf16 v[56:71], v[104:107], v[16:19], v[24:39]
    ds_read_b128 v[96:99], v6 offset:4096
    ds_read_b128 v[100:103], v6 offset:5120
    v_exp_f32 v40, v40
    v_exp_f32 v41, v41
    v_exp_f32 v42, v42
    v_exp_f32 v43, v43
    v_cvt_pk_bf16_f32 v72, v40, v41
    v_cvt_pk_bf16_f32 v73, v42, v43
    v_mfma_f32_32x32x16_bf16 v[80:95], v[124:127], v[76:79], v[80:95]
    ds_read_b128 v[120:123], v6 offset:18432
    ds_read_b128 v[124:127], v6 offset:19456
    v_exp_f32 v44, v44
    v_exp_f32 v45, v45
    v_exp_f32 v46, v46
    v_exp_f32 v47, v47
    v_cvt_pk_bf16_f32 v74, v44, v45
    v_cvt_pk_bf16_f32 v75, v46, v47
    v_mfma_f32_32x32x16_bf16 v[56:71], v[108:111], v[20:23], v[56:71]
    v_exp_f32 v48, v48
    v_exp_f32 v49, v49
    v_exp_f32 v50, v50
    v_exp_f32 v51, v51
    v_cvt_pk_bf16_f32 v76, v48, v49
    v_cvt_pk_bf16_f32 v77, v50, v51
    s_waitcnt lgkmcnt(4)
    v_mfma_f32_32x32x16_bf16 v[80:95], v[112:115], v[72:75], v[80:95]
    v_exp_f32 v52, v52
    v_exp_f32 v53, v53
    v_exp_f32 v54, v54
    v_exp_f32 v55, v55
    v_cvt_pk_bf16_f32 v78, v52, v53
    v_cvt_pk_bf16_f32 v79, v54, v55
    s_waitcnt lgkmcnt(2)
    v_mfma_f32_32x32x16_bf16 v[40:55], v[96:99], v[16:19], v[24:39]
    ds_read_b128 v[104:107], v6 offset:6144
    ds_read_b128 v[108:111], v6 offset:7168
    v_exp_f32 v56, v56
    v_exp_f32 v57, v57
    v_exp_f32 v58, v58
    v_exp_f32 v59, v59
    v_cvt_pk_bf16_f32 v72, v56, v57
    v_cvt_pk_bf16_f32 v73, v58, v59
    v_mfma_f32_32x32x16_bf16 v[80:95], v[116:119], v[76:79], v[80:95]
    ds_read_b128 v[112:115], v6 offset:20480
    ds_read_b128 v[116:119], v6 offset:21504
    v_exp_f32 v60, v60
    v_exp_f32 v61, v61
    v_exp_f32 v62, v62
    v_exp_f32 v63, v63
    v_cvt_pk_bf16_f32 v74, v60, v61
    v_cvt_pk_bf16_f32 v75, v62, v63
    v_mfma_f32_32x32x16_bf16 v[40:55], v[100:103], v[20:23], v[40:55]
    v_exp_f32 v64, v64
    v_exp_f32 v65, v65
    v_exp_f32 v66, v66
    v_exp_f32 v67, v67
    v_cvt_pk_bf16_f32 v76, v64, v65
    v_cvt_pk_bf16_f32 v77, v66, v67
    s_waitcnt lgkmcnt(4)
    v_mfma_f32_32x32x16_bf16 v[80:95], v[120:123], v[72:75], v[80:95]
    v_exp_f32 v68, v68
    v_exp_f32 v69, v69
    v_exp_f32 v70, v70
    v_exp_f32 v71, v71
    v_cvt_pk_bf16_f32 v78, v68, v69
    v_cvt_pk_bf16_f32 v79, v70, v71
    s_waitcnt lgkmcnt(2)
    v_mfma_f32_32x32x16_bf16 v[56:71], v[104:107], v[16:19], v[24:39]
    s_waitcnt vmcnt(0)
    s_barrier
    ds_read_b128 v[96:99], v6 offset:32768
    ds_read_b128 v[100:103], v6 offset:33792
    v_exp_f32 v40, v40
    v_exp_f32 v41, v41
    v_exp_f32 v42, v42
    v_exp_f32 v43, v43
    v_cvt_pk_bf16_f32 v72, v40, v41
    v_cvt_pk_bf16_f32 v73, v42, v43
    v_mfma_f32_32x32x16_bf16 v[80:95], v[124:127], v[76:79], v[80:95]
    ds_read_b128 v[120:123], v6 offset:22528
    ds_read_b128 v[124:127], v6 offset:23552
    v_exp_f32 v44, v44
    v_exp_f32 v45, v45
    v_exp_f32 v46, v46
    v_exp_f32 v47, v47
    v_cvt_pk_bf16_f32 v74, v44, v45
    v_cvt_pk_bf16_f32 v75, v46, v47
    v_mfma_f32_32x32x16_bf16 v[56:71], v[108:111], v[20:23], v[56:71]
    v_exp_f32 v48, v48
    v_exp_f32 v49, v49
    v_exp_f32 v50, v50
    v_exp_f32 v51, v51
    v_cvt_pk_bf16_f32 v76, v48, v49
    v_cvt_pk_bf16_f32 v77, v50, v51
    s_waitcnt lgkmcnt(4)
    v_mfma_f32_32x32x16_bf16 v[80:95], v[112:115], v[72:75], v[80:95]
    v_exp_f32 v52, v52
    v_exp_f32 v53, v53
    v_exp_f32 v54, v54
    v_exp_f32 v55, v55
    v_cvt_pk_bf16_f32 v78, v52, v53
    v_cvt_pk_bf16_f32 v79, v54, v55
    s_waitcnt lgkmcnt(2)
    v_mfma_f32_32x32x16_bf16 v[40:55], v[96:99], v[16:19], v[24:39]
    ds_read_b128 v[104:107], v6 offset:34816
    ds_read_b128 v[108:111], v6 offset:35840
    v_exp_f32 v56, v56
    v_exp_f32 v57, v57
    v_exp_f32 v58, v58
    v_exp_f32 v59, v59
    v_cvt_pk_bf16_f32 v72, v56, v57
    v_cvt_pk_bf16_f32 v73, v58, v59
    v_mfma_f32_32x32x16_bf16 v[80:95], v[116:119], v[76:79], v[80:95]
    ds_read_b128 v[112:115], v6 offset:49152
    ds_read_b128 v[116:119], v6 offset:50176
    v_exp_f32 v60, v60
    v_exp_f32 v61, v61
    v_exp_f32 v62, v62
    v_exp_f32 v63, v63
    v_cvt_pk_bf16_f32 v74, v60, v61
    v_cvt_pk_bf16_f32 v75, v62, v63
    v_mfma_f32_32x32x16_bf16 v[40:55], v[100:103], v[20:23], v[40:55]
    v_exp_f32 v64, v64
    v_exp_f32 v65, v65
    v_exp_f32 v66, v66
    v_exp_f32 v67, v67
    v_cvt_pk_bf16_f32 v76, v64, v65
    v_cvt_pk_bf16_f32 v77, v66, v67
    s_waitcnt lgkmcnt(4)
    v_mfma_f32_32x32x16_bf16 v[80:95], v[120:123], v[72:75], v[80:95]
    v_exp_f32 v68, v68
    v_exp_f32 v69, v69
    v_exp_f32 v70, v70
    v_exp_f32 v71, v71
    v_cvt_pk_bf16_f32 v78, v68, v69
    v_cvt_pk_bf16_f32 v79, v70, v71
    s_waitcnt lgkmcnt(2)
    v_mfma_f32_32x32x16_bf16 v[56:71], v[104:107], v[16:19], v[24:39]
    ds_read_b128 v[96:99], v6 offset:36864
    ds_read_b128 v[100:103], v6 offset:37888
    v_exp_f32 v40, v40
    v_exp_f32 v41, v41
    v_exp_f32 v42, v42
    v_exp_f32 v43, v43
    v_cvt_pk_bf16_f32 v72, v40, v41
    v_cvt_pk_bf16_f32 v73, v42, v43
    v_mfma_f32_32x32x16_bf16 v[80:95], v[124:127], v[76:79], v[80:95]
    ds_read_b128 v[120:123], v6 offset:51200
    ds_read_b128 v[124:127], v6 offset:52224
    v_exp_f32 v44, v44
    v_exp_f32 v45, v45
    v_exp_f32 v46, v46
    v_exp_f32 v47, v47
    v_cvt_pk_bf16_f32 v74, v44, v45
    v_cvt_pk_bf16_f32 v75, v46, v47
    v_mfma_f32_32x32x16_bf16 v[56:71], v[108:111], v[20:23], v[56:71]
    v_exp_f32 v48, v48
    v_exp_f32 v49, v49
    v_exp_f32 v50, v50
    v_exp_f32 v51, v51
    v_cvt_pk_bf16_f32 v76, v48, v49
    v_cvt_pk_bf16_f32 v77, v50, v51
    s_waitcnt lgkmcnt(4)
    v_mfma_f32_32x32x16_bf16 v[80:95], v[112:115], v[72:75], v[80:95]
    v_exp_f32 v52, v52
    v_exp_f32 v53, v53
    v_exp_f32 v54, v54
    v_exp_f32 v55, v55
    v_cvt_pk_bf16_f32 v78, v52, v53
    v_cvt_pk_bf16_f32 v79, v54, v55
    s_waitcnt lgkmcnt(2)
    v_mfma_f32_32x32x16_bf16 v[40:55], v[96:99], v[16:19], v[24:39]
    ds_read_b128 v[104:107], v6 offset:38912
    ds_read_b128 v[108:111], v6 offset:39936
    v_exp_f32 v56, v56
    v_exp_f32 v57, v57
    v_exp_f32 v58, v58
    v_exp_f32 v59, v59
    v_cvt_pk_bf16_f32 v72, v56, v57
    v_cvt_pk_bf16_f32 v73, v58, v59
    v_mfma_f32_32x32x16_bf16 v[80:95], v[116:119], v[76:79], v[80:95]
    ds_read_b128 v[112:115], v6 offset:53248
    ds_read_b128 v[116:119], v6 offset:54272
    v_exp_f32 v60, v60
    v_exp_f32 v61, v61
    v_exp_f32 v62, v62
    v_exp_f32 v63, v63
    v_cvt_pk_bf16_f32 v74, v60, v61
    v_cvt_pk_bf16_f32 v75, v62, v63
    v_mfma_f32_32x32x16_bf16 v[40:55], v[100:103], v[20:23], v[40:55]
    v_exp_f32 v64, v64
    v_exp_f32 v65, v65
    v_exp_f32 v66, v66
    v_exp_f32 v67, v67
    v_cvt_pk_bf16_f32 v76, v64, v65
    v_cvt_pk_bf16_f32 v77, v66, v67
    s_waitcnt lgkmcnt(4)
    v_mfma_f32_32x32x16_bf16 v[80:95], v[120:123], v[72:75], v[80:95]
    v_exp_f32 v68, v68
    v_exp_f32 v69, v69
    v_exp_f32 v70, v70
    v_exp_f32 v71, v71
    v_cvt_pk_bf16_f32 v78, v68, v69
    v_cvt_pk_bf16_f32 v79, v70, v71
    s_waitcnt lgkmcnt(2)
    v_mfma_f32_32x32x16_bf16 v[56:71], v[104:107], v[16:19], v[24:39]
    v_exp_f32 v40, v40
    v_exp_f32 v41, v41
    v_exp_f32 v42, v42
    v_exp_f32 v43, v43
    v_cvt_pk_bf16_f32 v72, v40, v41
    v_cvt_pk_bf16_f32 v73, v42, v43
    v_mfma_f32_32x32x16_bf16 v[80:95], v[124:127], v[76:79], v[80:95]
    ds_read_b128 v[120:123], v6 offset:55296
    ds_read_b128 v[124:127], v6 offset:56320
    v_exp_f32 v44, v44
    v_exp_f32 v45, v45
    v_exp_f32 v46, v46
    v_exp_f32 v47, v47
    v_cvt_pk_bf16_f32 v74, v44, v45
    v_cvt_pk_bf16_f32 v75, v46, v47
    v_mfma_f32_32x32x16_bf16 v[56:71], v[108:111], v[20:23], v[56:71]
    v_exp_f32 v48, v48
    v_exp_f32 v49, v49
    v_exp_f32 v50, v50
    v_exp_f32 v51, v51
    v_cvt_pk_bf16_f32 v76, v48, v49
    v_cvt_pk_bf16_f32 v77, v50, v51
    s_waitcnt lgkmcnt(2)
    v_mfma_f32_32x32x16_bf16 v[80:95], v[112:115], v[72:75], v[80:95]
    v_exp_f32 v52, v52
    v_exp_f32 v53, v53
    v_exp_f32 v54, v54
    v_exp_f32 v55, v55
    v_cvt_pk_bf16_f32 v78, v52, v53
    v_cvt_pk_bf16_f32 v79, v54, v55
    v_exp_f32 v56, v56
    v_exp_f32 v57, v57
    v_exp_f32 v58, v58
    v_exp_f32 v59, v59
    v_cvt_pk_bf16_f32 v72, v56, v57
    v_cvt_pk_bf16_f32 v73, v58, v59
    v_mfma_f32_32x32x16_bf16 v[80:95], v[116:119], v[76:79], v[80:95]
    v_exp_f32 v60, v60
    v_exp_f32 v61, v61
    v_exp_f32 v62, v62
    v_exp_f32 v63, v63
    v_cvt_pk_bf16_f32 v74, v60, v61
    v_cvt_pk_bf16_f32 v75, v62, v63
    v_exp_f32 v64, v64
    v_exp_f32 v65, v65
    v_exp_f32 v66, v66
    v_exp_f32 v67, v67
    v_cvt_pk_bf16_f32 v76, v64, v65
    v_cvt_pk_bf16_f32 v77, v66, v67
    s_waitcnt lgkmcnt(0)
    v_mfma_f32_32x32x16_bf16 v[80:95], v[120:123], v[72:75], v[80:95]
    v_exp_f32 v68, v68
    v_exp_f32 v69, v69
    v_exp_f32 v70, v70
    v_exp_f32 v71, v71
    v_cvt_pk_bf16_f32 v78, v68, v69
    v_cvt_pk_bf16_f32 v79, v70, v71
    s_nop 1
    v_mfma_f32_32x32x16_bf16 v[80:95], v[124:127], v[76:79], v[80:95]
    v_sub_f32 v15, 1.0, v9
    s_nop 10
    v_add_f32 v13, |v80|, |v81|
    v_add_f32 v13, v13, |v82|
    v_add_f32 v13, v13, |v83|
    v_add_f32 v13, v13, |v84|
    v_add_f32 v13, v13, |v85|
    v_add_f32 v13, v13, |v86|
    v_add_f32 v13, v13, |v87|
    v_add_f32 v13, v13, |v88|
    v_add_f32 v13, v13, |v89|
    v_add_f32 v13, v13, |v90|
    v_add_f32 v13, v13, |v91|
    v_add_f32 v13, v13, |v92|
    v_add_f32 v13, v13, |v93|
    v_add_f32 v13, v13, |v94|
    v_add_f32 v13, v13, |v95|
    v_mov_b32 v14, 0x7b800000
    v_cmp_nlt_f32 vcc, v13, v14
    s_cbranch_vccz K2_OKFAST
    v_mov_b32 v10, 1
    v_mov_b32 v11, 151552
    ds_write_b32 v11, v10
K2_OKFAST:
    s_mul_i32 s38, s23, 5120
    s_add_u32 s38, s38, 131072
    v_add_u32 v10, s38, v3
    s_cmp_eq_u32 s24, 0
    s_cbranch_scc1 K2_C1_F
    ds_write_b128 v10, v[80:83] offset:0
    ds_write_b128 v10, v[84:87] offset:1024
    ds_write_b128 v10, v[88:91] offset:2048
    ds_write_b128 v10, v[92:95] offset:3072
    ds_write_b32 v10, v12 offset:4096
K2_C1_F:
    s_waitcnt lgkmcnt(0)
    s_barrier
    v_mov_b32 v11, 151552
    ds_read_b32 v11, v11
    s_waitcnt lgkmcnt(0)
    v_readfirstlane_b32 s38, v11
    s_cmp_eq_u32 s38, 0
    s_cbranch_scc1 K2_MERGE
    s_barrier
    s_waitcnt vmcnt(0)
    s_add_u32 s36, s26, 0
    s_mov_b32 m0, s36
    s_add_u32 s37, s29, 4194304
    buffer_load_dwordx4 v4, s[8:11], s37 offen lds
    buffer_load_dwordx4 v4, s[8:11], s37 offen offset:1024 lds
    s_add_u32 s36, s26, 16384
    s_mov_b32 m0, s36
    s_add_u32 s37, s29, 8388608
    buffer_load_dwordx4 v4, s[8:11], s37 offen lds
    buffer_load_dwordx4 v4, s[8:11], s37 offen offset:1024 lds
    s_add_u32 s36, s26, 32768
    s_mov_b32 m0, s36
    s_add_u32 s37, s29, 4210688
    buffer_load_dwordx4 v4, s[8:11], s37 offen lds
    buffer_load_dwordx4 v4, s[8:11], s37 offen offset:1024 lds
    s_add_u32 s36, s26, 49152
    s_mov_b32 m0, s36
    s_add_u32 s37, s29, 8404992
    buffer_load_dwordx4 v4, s[8:11], s37 offen lds
    buffer_load_dwordx4 v4, s[8:11], s37 offen offset:1024 lds
    s_add_u32 s36, s26, 65536
    s_mov_b32 m0, s36
    s_add_u32 s37, s29, 4227072
    buffer_load_dwordx4 v4, s[8:11], s37 offen lds
    buffer_load_dwordx4 v4, s[8:11], s37 offen offset:1024 lds
    s_add_u32 s36, s26, 81920
    s_mov_b32 m0, s36
    s_add_u32 s37, s29, 8421376
    buffer_load_dwordx4 v4, s[8:11], s37 offen lds
    buffer_load_dwordx4 v4, s[8:11], s37 offen offset:1024 lds
    s_add_u32 s36, s26, 98304
    s_mov_b32 m0, s36
    s_add_u32 s37, s29, 4243456
    buffer_load_dwordx4 v4, s[8:11], s37 offen lds
    buffer_load_dwordx4 v4, s[8:11], s37 offen offset:1024 lds
    s_add_u32 s36, s26, 114688
    s_mov_b32 m0, s36
    s_add_u32 s37, s29, 8437760
    buffer_load_dwordx4 v4, s[8:11], s37 offen lds
    buffer_load_dwordx4 v4, s[8:11], s37 offen offset:1024 lds
    v_mov_b32 v12, 0xff7fffff
    v_mov_b32 v80, 0
    v_mov_b32 v81, 0
    v_mov_b32 v82, 0
    v_mov_b32 v83, 0
    v_mov_b32 v84, 0
    v_mov_b32 v85, 0
    v_mov_b32 v86, 0
    v_mov_b32 v87, 0
    v_mov_b32 v88, 0
    v_mov_b32 v89, 0
    v_mov_b32 v90, 0
    v_mov_b32 v91, 0
    v_mov_b32 v92, 0
    v_mov_b32 v93, 0
    v_mov_b32 v94, 0
    v_mov_b32 v95, 0
    s_waitcnt vmcnt(12)
    s_barrier
    ds_read_b128 v[96:99], v5 offset:0
    ds_read_b128 v[100:103], v5 offset:1024
    ds_read_b128 v[112:115], v5 offset:16384
    ds_read_b128 v[116:119], v5 offset:17408
    s_waitcnt lgkmcnt(0)
    v_mfma_f32_32x32x16_bf16 v[40:55], v[96:99], v[16:19], 0
    v_mfma_f32_32x32x16_bf16 v[40:55], v[100:103], v[20:23], v[40:55]
    s_nop 11
    v_max3_f32 v11, v40, v41, v42
    v_max3_f32 v11, v11, v43, v44
    v_max3_f32 v11, v11, v45, v46
    v_max3_f32 v11, v11, v47, v48
    v_max3_f32 v11, v11, v49, v50
    v_max3_f32 v11, v11, v51, v52
    v_max3_f32 v11, v11, v53, v54
    v_max_f32 v11, v11, v55
    v_mov_b32 v13, v11
    s_nop 1
    v_permlane32_swap_b32 v11, v13
    v_max_f32 v11, v11, v13
    v_max_f32 v11, v11, v12
    v_sub_f32 v10, v12, v11
    v_exp_f32 v10, v10
    v_mov_b32 v12, v11
    v_sub_f32 v40, v40, v11
    v_exp_f32 v40, v40
    v_sub_f32 v41, v41, v11
    v_exp_f32 v41, v41
    v_sub_f32 v42, v42, v11
    v_exp_f32 v42, v42
    v_sub_f32 v43, v43, v11
    v_exp_f32 v43, v43
    v_sub_f32 v44, v44, v11
    v_exp_f32 v44, v44
    v_sub_f32 v45, v45, v11
    v_exp_f32 v45, v45
    v_sub_f32 v46, v46, v11
    v_exp_f32 v46, v46
    v_sub_f32 v47, v47, v11
    v_exp_f32 v47, v47
    v_sub_f32 v48, v48, v11
    v_exp_f32 v48, v48
    v_sub_f32 v49, v49, v11
    v_exp_f32 v49, v49
    v_sub_f32 v50, v50, v11
    v_exp_f32 v50, v50
    v_sub_f32 v51, v51, v11
    v_exp_f32 v51, v51
    v_sub_f32 v52, v52, v11
    v_exp_f32 v52, v52
    v_sub_f32 v53, v53, v11
    v_exp_f32 v53, v53
    v_sub_f32 v54, v54, v11
    v_exp_f32 v54, v54
    v_sub_f32 v55, v55, v11
    v_exp_f32 v55, v55
    v_cvt_pk_bf16_f32 v72, v40, v41
    v_cvt_pk_bf16_f32 v73, v42, v43
    v_cvt_pk_bf16_f32 v74, v44, v45
    v_cvt_pk_bf16_f32 v75, v46, v47
    v_cvt_pk_bf16_f32 v76, v48, v49
    v_cvt_pk_bf16_f32 v77, v50, v51
    v_cvt_pk_bf16_f32 v78, v52, v53
    v_cvt_pk_bf16_f32 v79, v54, v55
    v_mul_f32 v80, v10, v80
    v_mul_f32 v81, v10, v81
    v_mul_f32 v82, v10, v82
    v_mul_f32 v83, v10, v83
    v_mul_f32 v84, v10, v84
    v_mul_f32 v85, v10, v85
    v_mul_f32 v86, v10, v86
    v_mul_f32 v87, v10, v87
    v_mul_f32 v88, v10, v88
    v_mul_f32 v89, v10, v89
    v_mul_f32 v90, v10, v90
    v_mul_f32 v91, v10, v91
    v_mul_f32 v92, v10, v92
    v_mul_f32 v93, v10, v93
    v_mul_f32 v94, v10, v94
    v_mul_f32 v95, v10, v95
    s_nop 1
    v_mfma_f32_32x32x16_bf16 v[80:95], v[112:115], v[72:75], v[80:95]
    v_mfma_f32_32x32x16_bf16 v[80:95], v[116:119], v[76:79], v[80:95]
    ds_read_b128 v[104:107], v5 offset:2048
    ds_read_b128 v[108:111], v5 offset:3072
    ds_read_b128 v[120:123], v5 offset:18432
    ds_read_b128 v[124:127], v5 offset:19456
    s_waitcnt lgkmcnt(0)
    v_mfma_f32_32x32x16_bf16 v[56:71], v[104:107], v[16:19], 0
    v_mfma_f32_32x32x16_bf16 v[56:71], v[108:111], v[20:23], v[56:71]
    s_nop 11
    v_max3_f32 v11, v56, v57, v58
    v_max3_f32 v11, v11, v59, v60
    v_max3_f32 v11, v11, v61, v62
    v_max3_f32 v11, v11, v63, v64
    v_max3_f32 v11, v11, v65, v66
    v_max3_f32 v11, v11, v67, v68
    v_max3_f32 v11, v11, v69, v70
    v_max_f32 v11, v11, v71
    v_mov_b32 v13, v11
    s_nop 1
    v_permlane32_swap_b32 v11, v13
    v_max_f32 v11, v11, v13
    v_max_f32 v11, v11, v12
    v_sub_f32 v10, v12, v11
    v_exp_f32 v10, v10
    v_mov_b32 v12, v11
    v_sub_f32 v56, v56, v11
    v_exp_f32 v56, v56
    v_sub_f32 v57, v57, v11
    v_exp_f32 v57, v57
    v_sub_f32 v58, v58, v11
    v_exp_f32 v58, v58
    v_sub_f32 v59, v59, v11
    v_exp_f32 v59, v59
    v_sub_f32 v60, v60, v11
    v_exp_f32 v60, v60
    v_sub_f32 v61, v61, v11
    v_exp_f32 v61, v61
    v_sub_f32 v62, v62, v11
    v_exp_f32 v62, v62
    v_sub_f32 v63, v63, v11
    v_exp_f32 v63, v63
    v_sub_f32 v64, v64, v11
    v_exp_f32 v64, v64
    v_sub_f32 v65, v65, v11
    v_exp_f32 v65, v65
    v_sub_f32 v66, v66, v11
    v_exp_f32 v66, v66
    v_sub_f32 v67, v67, v11
    v_exp_f32 v67, v67
    v_sub_f32 v68, v68, v11
    v_exp_f32 v68, v68
    v_sub_f32 v69, v69, v11
    v_exp_f32 v69, v69
    v_sub_f32 v70, v70, v11
    v_exp_f32 v70, v70
    v_sub_f32 v71, v71, v11
    v_exp_f32 v71, v71
    v_cvt_pk_bf16_f32 v72, v56, v57
    v_cvt_pk_bf16_f32 v73, v58, v59
    v_cvt_pk_bf16_f32 v74, v60, v61
    v_cvt_pk_bf16_f32 v75, v62, v63
    v_cvt_pk_bf16_f32 v76, v64, v65
    v_cvt_pk_bf16_f32 v77, v66, v67
    v_cvt_pk_bf16_f32 v78, v68, v69
    v_cvt_pk_bf16_f32 v79, v70, v71
    v_mul_f32 v80, v10, v80
    v_mul_f32 v81, v10, v81
    v_mul_f32 v82, v10, v82
    v_mul_f32 v83, v10, v83
    v_mul_f32 v84, v10, v84
    v_mul_f32 v85, v10, v85
    v_mul_f32 v86, v10, v86
    v_mul_f32 v87, v10, v87
    v_mul_f32 v88, v10, v88
    v_mul_f32 v89, v10, v89
    v_mul_f32 v90, v10, v90
    v_mul_f32 v91, v10, v91
    v_mul_f32 v92, v10, v92
    v_mul_f32 v93, v10, v93
    v_mul_f32 v94, v10, v94
    v_mul_f32 v95, v10, v95
    s_nop 1
    v_mfma_f32_32x32x16_bf16 v[80:95], v[120:123], v[72:75], v[80:95]
    v_mfma_f32_32x32x16_bf16 v[80:95], v[124:127], v[76:79], v[80:95]
    ds_read_b128 v[96:99], v5 offset:4096
    ds_read_b128 v[100:103], v5 offset:5120
    ds_read_b128 v[112:115], v5 offset:20480
    ds_read_b128 v[116:119], v5 offset:21504
    s_waitcnt lgkmcnt(0)
    v_mfma_f32_32x32x16_bf16 v[40:55], v[96:99], v[16:19], 0
    v_mfma_f32_32x32x16_bf16 v[40:55], v[100:103], v[20:23], v[40:55]
    s_nop 11
    v_max3_f32 v11, v40, v41, v42
    v_max3_f32 v11, v11, v43, v44
    v_max3_f32 v11, v11, v45, v46
    v_max3_f32 v11, v11, v47, v48
    v_max3_f32 v11, v11, v49, v50
    v_max3_f32 v11, v11, v51, v52
    v_max3_f32 v11, v11, v53, v54
    v_max_f32 v11, v11, v55
    v_mov_b32 v13, v11
    s_nop 1
    v_permlane32_swap_b32 v11, v13
    v_max_f32 v11, v11, v13
    v_max_f32 v11, v11, v12
    v_sub_f32 v10, v12, v11
    v_exp_f32 v10, v10
    v_mov_b32 v12, v11
    v_sub_f32 v40, v40, v11
    v_exp_f32 v40, v40
    v_sub_f32 v41, v41, v11
    v_exp_f32 v41, v41
    v_sub_f32 v42, v42, v11
    v_exp_f32 v42, v42
    v_sub_f32 v43, v43, v11
    v_exp_f32 v43, v43
    v_sub_f32 v44, v44, v11
    v_exp_f32 v44, v44
    v_sub_f32 v45, v45, v11
    v_exp_f32 v45, v45
    v_sub_f32 v46, v46, v11
    v_exp_f32 v46, v46
    v_sub_f32 v47, v47, v11
    v_exp_f32 v47, v47
    v_sub_f32 v48, v48, v11
    v_exp_f32 v48, v48
    v_sub_f32 v49, v49, v11
    v_exp_f32 v49, v49
    v_sub_f32 v50, v50, v11
    v_exp_f32 v50, v50
    v_sub_f32 v51, v51, v11
    v_exp_f32 v51, v51
    v_sub_f32 v52, v52, v11
    v_exp_f32 v52, v52
    v_sub_f32 v53, v53, v11
    v_exp_f32 v53, v53
    v_sub_f32 v54, v54, v11
    v_exp_f32 v54, v54
    v_sub_f32 v55, v55, v11
    v_exp_f32 v55, v55
    v_cvt_pk_bf16_f32 v72, v40, v41
    v_cvt_pk_bf16_f32 v73, v42, v43
    v_cvt_pk_bf16_f32 v74, v44, v45
    v_cvt_pk_bf16_f32 v75, v46, v47
    v_cvt_pk_bf16_f32 v76, v48, v49
    v_cvt_pk_bf16_f32 v77, v50, v51
    v_cvt_pk_bf16_f32 v78, v52, v53
    v_cvt_pk_bf16_f32 v79, v54, v55
    v_mul_f32 v80, v10, v80
    v_mul_f32 v81, v10, v81
    v_mul_f32 v82, v10, v82
    v_mul_f32 v83, v10, v83
    v_mul_f32 v84, v10, v84
    v_mul_f32 v85, v10, v85
    v_mul_f32 v86, v10, v86
    v_mul_f32 v87, v10, v87
    v_mul_f32 v88, v10, v88
    v_mul_f32 v89, v10, v89
    v_mul_f32 v90, v10, v90
    v_mul_f32 v91, v10, v91
    v_mul_f32 v92, v10, v92
    v_mul_f32 v93, v10, v93
    v_mul_f32 v94, v10, v94
    v_mul_f32 v95, v10, v95
    s_nop 1
    v_mfma_f32_32x32x16_bf16 v[80:95], v[112:115], v[72:75], v[80:95]
    v_mfma_f32_32x32x16_bf16 v[80:95], v[116:119], v[76:79], v[80:95]
    ds_read_b128 v[104:107], v5 offset:6144
    ds_read_b128 v[108:111], v5 offset:7168
    ds_read_b128 v[120:123], v5 offset:22528
    ds_read_b128 v[124:127], v5 offset:23552
    s_waitcnt lgkmcnt(0)
    v_mfma_f32_32x32x16_bf16 v[56:71], v[104:107], v[16:19], 0
    v_mfma_f32_32x32x16_bf16 v[56:71], v[108:111], v[20:23], v[56:71]
    s_nop 11
    v_max3_f32 v11, v56, v57, v58
    v_max3_f32 v11, v11, v59, v60
    v_max3_f32 v11, v11, v61, v62
    v_max3_f32 v11, v11, v63, v64
    v_max3_f32 v11, v11, v65, v66
    v_max3_f32 v11, v11, v67, v68
    v_max3_f32 v11, v11, v69, v70
    v_max_f32 v11, v11, v71
    v_mov_b32 v13, v11
    s_nop 1
    v_permlane32_swap_b32 v11, v13
    v_max_f32 v11, v11, v13
    v_max_f32 v11, v11, v12
    v_sub_f32 v10, v12, v11
    v_exp_f32 v10, v10
    v_mov_b32 v12, v11
    v_sub_f32 v56, v56, v11
    v_exp_f32 v56, v56
    v_sub_f32 v57, v57, v11
    v_exp_f32 v57, v57
    v_sub_f32 v58, v58, v11
    v_exp_f32 v58, v58
    v_sub_f32 v59, v59, v11
    v_exp_f32 v59, v59
    v_sub_f32 v60, v60, v11
    v_exp_f32 v60, v60
    v_sub_f32 v61, v61, v11
    v_exp_f32 v61, v61
    v_sub_f32 v62, v62, v11
    v_exp_f32 v62, v62
    v_sub_f32 v63, v63, v11
    v_exp_f32 v63, v63
    v_sub_f32 v64, v64, v11
    v_exp_f32 v64, v64
    v_sub_f32 v65, v65, v11
    v_exp_f32 v65, v65
    v_sub_f32 v66, v66, v11
    v_exp_f32 v66, v66
    v_sub_f32 v67, v67, v11
    v_exp_f32 v67, v67
    v_sub_f32 v68, v68, v11
    v_exp_f32 v68, v68
    v_sub_f32 v69, v69, v11
    v_exp_f32 v69, v69
    v_sub_f32 v70, v70, v11
    v_exp_f32 v70, v70
    v_sub_f32 v71, v71, v11
    v_exp_f32 v71, v71
    v_cvt_pk_bf16_f32 v72, v56, v57
    v_cvt_pk_bf16_f32 v73, v58, v59
    v_cvt_pk_bf16_f32 v74, v60, v61
    v_cvt_pk_bf16_f32 v75, v62, v63
    v_cvt_pk_bf16_f32 v76, v64, v65
    v_cvt_pk_bf16_f32 v77, v66, v67
    v_cvt_pk_bf16_f32 v78, v68, v69
    v_cvt_pk_bf16_f32 v79, v70, v71
    v_mul_f32 v80, v10, v80
    v_mul_f32 v81, v10, v81
    v_mul_f32 v82, v10, v82
    v_mul_f32 v83, v10, v83
    v_mul_f32 v84, v10, v84
    v_mul_f32 v85, v10, v85
    v_mul_f32 v86, v10, v86
    v_mul_f32 v87, v10, v87
    v_mul_f32 v88, v10, v88
    v_mul_f32 v89, v10, v89
    v_mul_f32 v90, v10, v90
    v_mul_f32 v91, v10, v91
    v_mul_f32 v92, v10, v92
    v_mul_f32 v93, v10, v93
    v_mul_f32 v94, v10, v94
    v_mul_f32 v95, v10, v95
    s_nop 1
    v_mfma_f32_32x32x16_bf16 v[80:95], v[120:123], v[72:75], v[80:95]
    v_mfma_f32_32x32x16_bf16 v[80:95], v[124:127], v[76:79], v[80:95]
    s_waitcnt vmcnt(8)
    s_barrier
    ds_read_b128 v[96:99], v5 offset:32768
    ds_read_b128 v[100:103], v5 offset:33792
    ds_read_b128 v[112:115], v5 offset:49152
    ds_read_b128 v[116:119], v5 offset:50176
    s_waitcnt lgkmcnt(0)
    v_mfma_f32_32x32x16_bf16 v[40:55], v[96:99], v[16:19], 0
    v_mfma_f32_32x32x16_bf16 v[40:55], v[100:103], v[20:23], v[40:55]
    s_nop 11
    v_max3_f32 v11, v40, v41, v42
    v_max3_f32 v11, v11, v43, v44
    v_max3_f32 v11, v11, v45, v46
    v_max3_f32 v11, v11, v47, v48
    v_max3_f32 v11, v11, v49, v50
    v_max3_f32 v11, v11, v51, v52
    v_max3_f32 v11, v11, v53, v54
    v_max_f32 v11, v11, v55
    v_mov_b32 v13, v11
    s_nop 1
    v_permlane32_swap_b32 v11, v13
    v_max_f32 v11, v11, v13
    v_max_f32 v11, v11, v12
    v_sub_f32 v10, v12, v11
    v_exp_f32 v10, v10
    v_mov_b32 v12, v11
    v_sub_f32 v40, v40, v11
    v_exp_f32 v40, v40
    v_sub_f32 v41, v41, v11
    v_exp_f32 v41, v41
    v_sub_f32 v42, v42, v11
    v_exp_f32 v42, v42
    v_sub_f32 v43, v43, v11
    v_exp_f32 v43, v43
    v_sub_f32 v44, v44, v11
    v_exp_f32 v44, v44
    v_sub_f32 v45, v45, v11
    v_exp_f32 v45, v45
    v_sub_f32 v46, v46, v11
    v_exp_f32 v46, v46
    v_sub_f32 v47, v47, v11
    v_exp_f32 v47, v47
    v_sub_f32 v48, v48, v11
    v_exp_f32 v48, v48
    v_sub_f32 v49, v49, v11
    v_exp_f32 v49, v49
    v_sub_f32 v50, v50, v11
    v_exp_f32 v50, v50
    v_sub_f32 v51, v51, v11
    v_exp_f32 v51, v51
    v_sub_f32 v52, v52, v11
    v_exp_f32 v52, v52
    v_sub_f32 v53, v53, v11
    v_exp_f32 v53, v53
    v_sub_f32 v54, v54, v11
    v_exp_f32 v54, v54
    v_sub_f32 v55, v55, v11
    v_exp_f32 v55, v55
    v_cvt_pk_bf16_f32 v72, v40, v41
    v_cvt_pk_bf16_f32 v73, v42, v43
    v_cvt_pk_bf16_f32 v74, v44, v45
    v_cvt_pk_bf16_f32 v75, v46, v47
    v_cvt_pk_bf16_f32 v76, v48, v49
    v_cvt_pk_bf16_f32 v77, v50, v51
    v_cvt_pk_bf16_f32 v78, v52, v53
    v_cvt_pk_bf16_f32 v79, v54, v55
    v_mul_f32 v80, v10, v80
    v_mul_f32 v81, v10, v81
    v_mul_f32 v82, v10, v82
    v_mul_f32 v83, v10, v83
    v_mul_f32 v84, v10, v84
    v_mul_f32 v85, v10, v85
    v_mul_f32 v86, v10, v86
    v_mul_f32 v87, v10, v87
    v_mul_f32 v88, v10, v88
    v_mul_f32 v89, v10, v89
    v_mul_f32 v90, v10, v90
    v_mul_f32 v91, v10, v91
    v_mul_f32 v92, v10, v92
    v_mul_f32 v93, v10, v93
    v_mul_f32 v94, v10, v94
    v_mul_f32 v95, v10, v95
    s_nop 1
    v_mfma_f32_32x32x16_bf16 v[80:95], v[112:115], v[72:75], v[80:95]
    v_mfma_f32_32x32x16_bf16 v[80:95], v[116:119], v[76:79], v[80:95]
    ds_read_b128 v[104:107], v5 offset:34816
    ds_read_b128 v[108:111], v5 offset:35840
    ds_read_b128 v[120:123], v5 offset:51200
    ds_read_b128 v[124:127], v5 offset:52224
    s_waitcnt lgkmcnt(0)
    v_mfma_f32_32x32x16_bf16 v[56:71], v[104:107], v[16:19], 0
    v_mfma_f32_32x32x16_bf16 v[56:71], v[108:111], v[20:23], v[56:71]
    s_nop 11
    v_max3_f32 v11, v56, v57, v58
    v_max3_f32 v11, v11, v59, v60
    v_max3_f32 v11, v11, v61, v62
    v_max3_f32 v11, v11, v63, v64
    v_max3_f32 v11, v11, v65, v66
    v_max3_f32 v11, v11, v67, v68
    v_max3_f32 v11, v11, v69, v70
    v_max_f32 v11, v11, v71
    v_mov_b32 v13, v11
    s_nop 1
    v_permlane32_swap_b32 v11, v13
    v_max_f32 v11, v11, v13
    v_max_f32 v11, v11, v12
    v_sub_f32 v10, v12, v11
    v_exp_f32 v10, v10
    v_mov_b32 v12, v11
    v_sub_f32 v56, v56, v11
    v_exp_f32 v56, v56
    v_sub_f32 v57, v57, v11
    v_exp_f32 v57, v57
    v_sub_f32 v58, v58, v11
    v_exp_f32 v58, v58
    v_sub_f32 v59, v59, v11
    v_exp_f32 v59, v59
    v_sub_f32 v60, v60, v11
    v_exp_f32 v60, v60
    v_sub_f32 v61, v61, v11
    v_exp_f32 v61, v61
    v_sub_f32 v62, v62, v11
    v_exp_f32 v62, v62
    v_sub_f32 v63, v63, v11
    v_exp_f32 v63, v63
    v_sub_f32 v64, v64, v11
    v_exp_f32 v64, v64
    v_sub_f32 v65, v65, v11
    v_exp_f32 v65, v65
    v_sub_f32 v66, v66, v11
    v_exp_f32 v66, v66
    v_sub_f32 v67, v67, v11
    v_exp_f32 v67, v67
    v_sub_f32 v68, v68, v11
    v_exp_f32 v68, v68
    v_sub_f32 v69, v69, v11
    v_exp_f32 v69, v69
    v_sub_f32 v70, v70, v11
    v_exp_f32 v70, v70
    v_sub_f32 v71, v71, v11
    v_exp_f32 v71, v71
    v_cvt_pk_bf16_f32 v72, v56, v57
    v_cvt_pk_bf16_f32 v73, v58, v59
    v_cvt_pk_bf16_f32 v74, v60, v61
    v_cvt_pk_bf16_f32 v75, v62, v63
    v_cvt_pk_bf16_f32 v76, v64, v65
    v_cvt_pk_bf16_f32 v77, v66, v67
    v_cvt_pk_bf16_f32 v78, v68, v69
    v_cvt_pk_bf16_f32 v79, v70, v71
    v_mul_f32 v80, v10, v80
    v_mul_f32 v81, v10, v81
    v_mul_f32 v82, v10, v82
    v_mul_f32 v83, v10, v83
    v_mul_f32 v84, v10, v84
    v_mul_f32 v85, v10, v85
    v_mul_f32 v86, v10, v86
    v_mul_f32 v87, v10, v87
    v_mul_f32 v88, v10, v88
    v_mul_f32 v89, v10, v89
    v_mul_f32 v90, v10, v90
    v_mul_f32 v91, v10, v91
    v_mul_f32 v92, v10, v92
    v_mul_f32 v93, v10, v93
    v_mul_f32 v94, v10, v94
    v_mul_f32 v95, v10, v95
    s_nop 1
    v_mfma_f32_32x32x16_bf16 v[80:95], v[120:123], v[72:75], v[80:95]
    v_mfma_f32_32x32x16_bf16 v[80:95], v[124:127], v[76:79], v[80:95]
    ds_read_b128 v[96:99], v5 offset:36864
    ds_read_b128 v[100:103], v5 offset:37888
    ds_read_b128 v[112:115], v5 offset:53248
    ds_read_b128 v[116:119], v5 offset:54272
    s_waitcnt lgkmcnt(0)
    v_mfma_f32_32x32x16_bf16 v[40:55], v[96:99], v[16:19], 0
    v_mfma_f32_32x32x16_bf16 v[40:55], v[100:103], v[20:23], v[40:55]
    s_nop 11
    v_max3_f32 v11, v40, v41, v42
    v_max3_f32 v11, v11, v43, v44
    v_max3_f32 v11, v11, v45, v46
    v_max3_f32 v11, v11, v47, v48
    v_max3_f32 v11, v11, v49, v50
    v_max3_f32 v11, v11, v51, v52
    v_max3_f32 v11, v11, v53, v54
    v_max_f32 v11, v11, v55
    v_mov_b32 v13, v11
    s_nop 1
    v_permlane32_swap_b32 v11, v13
    v_max_f32 v11, v11, v13
    v_max_f32 v11, v11, v12
    v_sub_f32 v10, v12, v11
    v_exp_f32 v10, v10
    v_mov_b32 v12, v11
    v_sub_f32 v40, v40, v11
    v_exp_f32 v40, v40
    v_sub_f32 v41, v41, v11
    v_exp_f32 v41, v41
    v_sub_f32 v42, v42, v11
    v_exp_f32 v42, v42
    v_sub_f32 v43, v43, v11
    v_exp_f32 v43, v43
    v_sub_f32 v44, v44, v11
    v_exp_f32 v44, v44
    v_sub_f32 v45, v45, v11
    v_exp_f32 v45, v45
    v_sub_f32 v46, v46, v11
    v_exp_f32 v46, v46
    v_sub_f32 v47, v47, v11
    v_exp_f32 v47, v47
    v_sub_f32 v48, v48, v11
    v_exp_f32 v48, v48
    v_sub_f32 v49, v49, v11
    v_exp_f32 v49, v49
    v_sub_f32 v50, v50, v11
    v_exp_f32 v50, v50
    v_sub_f32 v51, v51, v11
    v_exp_f32 v51, v51
    v_sub_f32 v52, v52, v11
    v_exp_f32 v52, v52
    v_sub_f32 v53, v53, v11
    v_exp_f32 v53, v53
    v_sub_f32 v54, v54, v11
    v_exp_f32 v54, v54
    v_sub_f32 v55, v55, v11
    v_exp_f32 v55, v55
    v_cvt_pk_bf16_f32 v72, v40, v41
    v_cvt_pk_bf16_f32 v73, v42, v43
    v_cvt_pk_bf16_f32 v74, v44, v45
    v_cvt_pk_bf16_f32 v75, v46, v47
    v_cvt_pk_bf16_f32 v76, v48, v49
    v_cvt_pk_bf16_f32 v77, v50, v51
    v_cvt_pk_bf16_f32 v78, v52, v53
    v_cvt_pk_bf16_f32 v79, v54, v55
    v_mul_f32 v80, v10, v80
    v_mul_f32 v81, v10, v81
    v_mul_f32 v82, v10, v82
    v_mul_f32 v83, v10, v83
    v_mul_f32 v84, v10, v84
    v_mul_f32 v85, v10, v85
    v_mul_f32 v86, v10, v86
    v_mul_f32 v87, v10, v87
    v_mul_f32 v88, v10, v88
    v_mul_f32 v89, v10, v89
    v_mul_f32 v90, v10, v90
    v_mul_f32 v91, v10, v91
    v_mul_f32 v92, v10, v92
    v_mul_f32 v93, v10, v93
    v_mul_f32 v94, v10, v94
    v_mul_f32 v95, v10, v95
    s_nop 1
    v_mfma_f32_32x32x16_bf16 v[80:95], v[112:115], v[72:75], v[80:95]
    v_mfma_f32_32x32x16_bf16 v[80:95], v[116:119], v[76:79], v[80:95]
    ds_read_b128 v[104:107], v5 offset:38912
    ds_read_b128 v[108:111], v5 offset:39936
    ds_read_b128 v[120:123], v5 offset:55296
    ds_read_b128 v[124:127], v5 offset:56320
    s_waitcnt lgkmcnt(0)
    v_mfma_f32_32x32x16_bf16 v[56:71], v[104:107], v[16:19], 0
    v_mfma_f32_32x32x16_bf16 v[56:71], v[108:111], v[20:23], v[56:71]
    s_nop 11
    v_max3_f32 v11, v56, v57, v58
    v_max3_f32 v11, v11, v59, v60
    v_max3_f32 v11, v11, v61, v62
    v_max3_f32 v11, v11, v63, v64
    v_max3_f32 v11, v11, v65, v66
    v_max3_f32 v11, v11, v67, v68
    v_max3_f32 v11, v11, v69, v70
    v_max_f32 v11, v11, v71
    v_mov_b32 v13, v11
    s_nop 1
    v_permlane32_swap_b32 v11, v13
    v_max_f32 v11, v11, v13
    v_max_f32 v11, v11, v12
    v_sub_f32 v10, v12, v11
    v_exp_f32 v10, v10
    v_mov_b32 v12, v11
    v_sub_f32 v56, v56, v11
    v_exp_f32 v56, v56
    v_sub_f32 v57, v57, v11
    v_exp_f32 v57, v57
    v_sub_f32 v58, v58, v11
    v_exp_f32 v58, v58
    v_sub_f32 v59, v59, v11
    v_exp_f32 v59, v59
    v_sub_f32 v60, v60, v11
    v_exp_f32 v60, v60
    v_sub_f32 v61, v61, v11
    v_exp_f32 v61, v61
    v_sub_f32 v62, v62, v11
    v_exp_f32 v62, v62
    v_sub_f32 v63, v63, v11
    v_exp_f32 v63, v63
    v_sub_f32 v64, v64, v11
    v_exp_f32 v64, v64
    v_sub_f32 v65, v65, v11
    v_exp_f32 v65, v65
    v_sub_f32 v66, v66, v11
    v_exp_f32 v66, v66
    v_sub_f32 v67, v67, v11
    v_exp_f32 v67, v67
    v_sub_f32 v68, v68, v11
    v_exp_f32 v68, v68
    v_sub_f32 v69, v69, v11
    v_exp_f32 v69, v69
    v_sub_f32 v70, v70, v11
    v_exp_f32 v70, v70
    v_sub_f32 v71, v71, v11
    v_exp_f32 v71, v71
    v_cvt_pk_bf16_f32 v72, v56, v57
    v_cvt_pk_bf16_f32 v73, v58, v59
    v_cvt_pk_bf16_f32 v74, v60, v61
    v_cvt_pk_bf16_f32 v75, v62, v63
    v_cvt_pk_bf16_f32 v76, v64, v65
    v_cvt_pk_bf16_f32 v77, v66, v67
    v_cvt_pk_bf16_f32 v78, v68, v69
    v_cvt_pk_bf16_f32 v79, v70, v71
    v_mul_f32 v80, v10, v80
    v_mul_f32 v81, v10, v81
    v_mul_f32 v82, v10, v82
    v_mul_f32 v83, v10, v83
    v_mul_f32 v84, v10, v84
    v_mul_f32 v85, v10, v85
    v_mul_f32 v86, v10, v86
    v_mul_f32 v87, v10, v87
    v_mul_f32 v88, v10, v88
    v_mul_f32 v89, v10, v89
    v_mul_f32 v90, v10, v90
    v_mul_f32 v91, v10, v91
    v_mul_f32 v92, v10, v92
    v_mul_f32 v93, v10, v93
    v_mul_f32 v94, v10, v94
    v_mul_f32 v95, v10, v95
    s_nop 1
    v_mfma_f32_32x32x16_bf16 v[80:95], v[120:123], v[72:75], v[80:95]
    v_mfma_f32_32x32x16_bf16 v[80:95], v[124:127], v[76:79], v[80:95]
    s_waitcnt vmcnt(4)
    s_barrier
    s_add_u32 s36, s26, 0
    s_mov_b32 m0, s36
    s_add_u32 s37, s29, 4259840
    buffer_load_dwordx4 v4, s[8:11], s37 offen lds
    buffer_load_dwordx4 v4, s[8:11], s37 offen offset:1024 lds
    s_add_u32 s36, s26, 16384
    s_mov_b32 m0, s36
    s_add_u32 s37, s29, 8454144
    buffer_load_dwordx4 v4, s[8:11], s37 offen lds
    buffer_load_dwordx4 v4, s[8:11], s37 offen offset:1024 lds
    ds_read_b128 v[96:99], v6 offset:0
    ds_read_b128 v[100:103], v6 offset:1024
    ds_read_b128 v[112:115], v6 offset:16384
    ds_read_b128 v[116:119], v6 offset:17408
    s_waitcnt lgkmcnt(0)
    v_mfma_f32_32x32x16_bf16 v[40:55], v[96:99], v[16:19], 0
    v_mfma_f32_32x32x16_bf16 v[40:55], v[100:103], v[20:23], v[40:55]
    s_nop 11
    v_max3_f32 v11, v40, v41, v42
    v_max3_f32 v11, v11, v43, v44
    v_max3_f32 v11, v11, v45, v46
    v_max3_f32 v11, v11, v47, v48
    v_max3_f32 v11, v11, v49, v50
    v_max3_f32 v11, v11, v51, v52
    v_max3_f32 v11, v11, v53, v54
    v_max_f32 v11, v11, v55
    v_mov_b32 v13, v11
    s_nop 1
    v_permlane32_swap_b32 v11, v13
    v_max_f32 v11, v11, v13
    v_max_f32 v11, v11, v12
    v_sub_f32 v10, v12, v11
    v_exp_f32 v10, v10
    v_mov_b32 v12, v11
    v_sub_f32 v40, v40, v11
    v_exp_f32 v40, v40
    v_sub_f32 v41, v41, v11
    v_exp_f32 v41, v41
    v_sub_f32 v42, v42, v11
    v_exp_f32 v42, v42
    v_sub_f32 v43, v43, v11
    v_exp_f32 v43, v43
    v_sub_f32 v44, v44, v11
    v_exp_f32 v44, v44
    v_sub_f32 v45, v45, v11
    v_exp_f32 v45, v45
    v_sub_f32 v46, v46, v11
    v_exp_f32 v46, v46
    v_sub_f32 v47, v47, v11
    v_exp_f32 v47, v47
    v_sub_f32 v48, v48, v11
    v_exp_f32 v48, v48
    v_sub_f32 v49, v49, v11
    v_exp_f32 v49, v49
    v_sub_f32 v50, v50, v11
    v_exp_f32 v50, v50
    v_sub_f32 v51, v51, v11
    v_exp_f32 v51, v51
    v_sub_f32 v52, v52, v11
    v_exp_f32 v52, v52
    v_sub_f32 v53, v53, v11
    v_exp_f32 v53, v53
    v_sub_f32 v54, v54, v11
    v_exp_f32 v54, v54
    v_sub_f32 v55, v55, v11
    v_exp_f32 v55, v55
    v_cvt_pk_bf16_f32 v72, v40, v41
    v_cvt_pk_bf16_f32 v73, v42, v43
    v_cvt_pk_bf16_f32 v74, v44, v45
    v_cvt_pk_bf16_f32 v75, v46, v47
    v_cvt_pk_bf16_f32 v76, v48, v49
    v_cvt_pk_bf16_f32 v77, v50, v51
    v_cvt_pk_bf16_f32 v78, v52, v53
    v_cvt_pk_bf16_f32 v79, v54, v55
    v_mul_f32 v80, v10, v80
    v_mul_f32 v81, v10, v81
    v_mul_f32 v82, v10, v82
    v_mul_f32 v83, v10, v83
    v_mul_f32 v84, v10, v84
    v_mul_f32 v85, v10, v85
    v_mul_f32 v86, v10, v86
    v_mul_f32 v87, v10, v87
    v_mul_f32 v88, v10, v88
    v_mul_f32 v89, v10, v89
    v_mul_f32 v90, v10, v90
    v_mul_f32 v91, v10, v91
    v_mul_f32 v92, v10, v92
    v_mul_f32 v93, v10, v93
    v_mul_f32 v94, v10, v94
    v_mul_f32 v95, v10, v95
    s_nop 1
    v_mfma_f32_32x32x16_bf16 v[80:95], v[112:115], v[72:75], v[80:95]
    v_mfma_f32_32x32x16_bf16 v[80:95], v[116:119], v[76:79], v[80:95]
    ds_read_b128 v[104:107], v6 offset:2048
    ds_read_b128 v[108:111], v6 offset:3072
    ds_read_b128 v[120:123], v6 offset:18432
    ds_read_b128 v[124:127], v6 offset:19456
    s_waitcnt lgkmcnt(0)
    v_mfma_f32_32x32x16_bf16 v[56:71], v[104:107], v[16:19], 0
    v_mfma_f32_32x32x16_bf16 v[56:71], v[108:111], v[20:23], v[56:71]
    s_nop 11
    v_max3_f32 v11, v56, v57, v58
    v_max3_f32 v11, v11, v59, v60
    v_max3_f32 v11, v11, v61, v62
    v_max3_f32 v11, v11, v63, v64
    v_max3_f32 v11, v11, v65, v66
    v_max3_f32 v11, v11, v67, v68
    v_max3_f32 v11, v11, v69, v70
    v_max_f32 v11, v11, v71
    v_mov_b32 v13, v11
    s_nop 1
    v_permlane32_swap_b32 v11, v13
    v_max_f32 v11, v11, v13
    v_max_f32 v11, v11, v12
    v_sub_f32 v10, v12, v11
    v_exp_f32 v10, v10
    v_mov_b32 v12, v11
    v_sub_f32 v56, v56, v11
    v_exp_f32 v56, v56
    v_sub_f32 v57, v57, v11
    v_exp_f32 v57, v57
    v_sub_f32 v58, v58, v11
    v_exp_f32 v58, v58
    v_sub_f32 v59, v59, v11
    v_exp_f32 v59, v59
    v_sub_f32 v60, v60, v11
    v_exp_f32 v60, v60
    v_sub_f32 v61, v61, v11
    v_exp_f32 v61, v61
    v_sub_f32 v62, v62, v11
    v_exp_f32 v62, v62
    v_sub_f32 v63, v63, v11
    v_exp_f32 v63, v63
    v_sub_f32 v64, v64, v11
    v_exp_f32 v64, v64
    v_sub_f32 v65, v65, v11
    v_exp_f32 v65, v65
    v_sub_f32 v66, v66, v11
    v_exp_f32 v66, v66
    v_sub_f32 v67, v67, v11
    v_exp_f32 v67, v67
    v_sub_f32 v68, v68, v11
    v_exp_f32 v68, v68
    v_sub_f32 v69, v69, v11
    v_exp_f32 v69, v69
    v_sub_f32 v70, v70, v11
    v_exp_f32 v70, v70
    v_sub_f32 v71, v71, v11
    v_exp_f32 v71, v71
    v_cvt_pk_bf16_f32 v72, v56, v57
    v_cvt_pk_bf16_f32 v73, v58, v59
    v_cvt_pk_bf16_f32 v74, v60, v61
    v_cvt_pk_bf16_f32 v75, v62, v63
    v_cvt_pk_bf16_f32 v76, v64, v65
    v_cvt_pk_bf16_f32 v77, v66, v67
    v_cvt_pk_bf16_f32 v78, v68, v69
    v_cvt_pk_bf16_f32 v79, v70, v71
    v_mul_f32 v80, v10, v80
    v_mul_f32 v81, v10, v81
    v_mul_f32 v82, v10, v82
    v_mul_f32 v83, v10, v83
    v_mul_f32 v84, v10, v84
    v_mul_f32 v85, v10, v85
    v_mul_f32 v86, v10, v86
    v_mul_f32 v87, v10, v87
    v_mul_f32 v88, v10, v88
    v_mul_f32 v89, v10, v89
    v_mul_f32 v90, v10, v90
    v_mul_f32 v91, v10, v91
    v_mul_f32 v92, v10, v92
    v_mul_f32 v93, v10, v93
    v_mul_f32 v94, v10, v94
    v_mul_f32 v95, v10, v95
    s_nop 1
    v_mfma_f32_32x32x16_bf16 v[80:95], v[120:123], v[72:75], v[80:95]
    v_mfma_f32_32x32x16_bf16 v[80:95], v[124:127], v[76:79], v[80:95]
    ds_read_b128 v[96:99], v6 offset:4096
    ds_read_b128 v[100:103], v6 offset:5120
    ds_read_b128 v[112:115], v6 offset:20480
    ds_read_b128 v[116:119], v6 offset:21504
    s_waitcnt lgkmcnt(0)
    v_mfma_f32_32x32x16_bf16 v[40:55], v[96:99], v[16:19], 0
    v_mfma_f32_32x32x16_bf16 v[40:55], v[100:103], v[20:23], v[40:55]
    s_nop 11
    v_max3_f32 v11, v40, v41, v42
    v_max3_f32 v11, v11, v43, v44
    v_max3_f32 v11, v11, v45, v46
    v_max3_f32 v11, v11, v47, v48
    v_max3_f32 v11, v11, v49, v50
    v_max3_f32 v11, v11, v51, v52
    v_max3_f32 v11, v11, v53, v54
    v_max_f32 v11, v11, v55
    v_mov_b32 v13, v11
    s_nop 1
    v_permlane32_swap_b32 v11, v13
    v_max_f32 v11, v11, v13
    v_max_f32 v11, v11, v12
    v_sub_f32 v10, v12, v11
    v_exp_f32 v10, v10
    v_mov_b32 v12, v11
    v_sub_f32 v40, v40, v11
    v_exp_f32 v40, v40
    v_sub_f32 v41, v41, v11
    v_exp_f32 v41, v41
    v_sub_f32 v42, v42, v11
    v_exp_f32 v42, v42
    v_sub_f32 v43, v43, v11
    v_exp_f32 v43, v43
    v_sub_f32 v44, v44, v11
    v_exp_f32 v44, v44
    v_sub_f32 v45, v45, v11
    v_exp_f32 v45, v45
    v_sub_f32 v46, v46, v11
    v_exp_f32 v46, v46
    v_sub_f32 v47, v47, v11
    v_exp_f32 v47, v47
    v_sub_f32 v48, v48, v11
    v_exp_f32 v48, v48
    v_sub_f32 v49, v49, v11
    v_exp_f32 v49, v49
    v_sub_f32 v50, v50, v11
    v_exp_f32 v50, v50
    v_sub_f32 v51, v51, v11
    v_exp_f32 v51, v51
    v_sub_f32 v52, v52, v11
    v_exp_f32 v52, v52
    v_sub_f32 v53, v53, v11
    v_exp_f32 v53, v53
    v_sub_f32 v54, v54, v11
    v_exp_f32 v54, v54
    v_sub_f32 v55, v55, v11
    v_exp_f32 v55, v55
    v_cvt_pk_bf16_f32 v72, v40, v41
    v_cvt_pk_bf16_f32 v73, v42, v43
    v_cvt_pk_bf16_f32 v74, v44, v45
    v_cvt_pk_bf16_f32 v75, v46, v47
    v_cvt_pk_bf16_f32 v76, v48, v49
    v_cvt_pk_bf16_f32 v77, v50, v51
    v_cvt_pk_bf16_f32 v78, v52, v53
    v_cvt_pk_bf16_f32 v79, v54, v55
    v_mul_f32 v80, v10, v80
    v_mul_f32 v81, v10, v81
    v_mul_f32 v82, v10, v82
    v_mul_f32 v83, v10, v83
    v_mul_f32 v84, v10, v84
    v_mul_f32 v85, v10, v85
    v_mul_f32 v86, v10, v86
    v_mul_f32 v87, v10, v87
    v_mul_f32 v88, v10, v88
    v_mul_f32 v89, v10, v89
    v_mul_f32 v90, v10, v90
    v_mul_f32 v91, v10, v91
    v_mul_f32 v92, v10, v92
    v_mul_f32 v93, v10, v93
    v_mul_f32 v94, v10, v94
    v_mul_f32 v95, v10, v95
    s_nop 1
    v_mfma_f32_32x32x16_bf16 v[80:95], v[112:115], v[72:75], v[80:95]
    v_mfma_f32_32x32x16_bf16 v[80:95], v[116:119], v[76:79], v[80:95]
    ds_read_b128 v[104:107], v6 offset:6144
    ds_read_b128 v[108:111], v6 offset:7168
    ds_read_b128 v[120:123], v6 offset:22528
    ds_read_b128 v[124:127], v6 offset:23552
    s_waitcnt lgkmcnt(0)
    v_mfma_f32_32x32x16_bf16 v[56:71], v[104:107], v[16:19], 0
    v_mfma_f32_32x32x16_bf16 v[56:71], v[108:111], v[20:23], v[56:71]
    s_nop 11
    v_max3_f32 v11, v56, v57, v58
    v_max3_f32 v11, v11, v59, v60
    v_max3_f32 v11, v11, v61, v62
    v_max3_f32 v11, v11, v63, v64
    v_max3_f32 v11, v11, v65, v66
    v_max3_f32 v11, v11, v67, v68
    v_max3_f32 v11, v11, v69, v70
    v_max_f32 v11, v11, v71
    v_mov_b32 v13, v11
    s_nop 1
    v_permlane32_swap_b32 v11, v13
    v_max_f32 v11, v11, v13
    v_max_f32 v11, v11, v12
    v_sub_f32 v10, v12, v11
    v_exp_f32 v10, v10
    v_mov_b32 v12, v11
    v_sub_f32 v56, v56, v11
    v_exp_f32 v56, v56
    v_sub_f32 v57, v57, v11
    v_exp_f32 v57, v57
    v_sub_f32 v58, v58, v11
    v_exp_f32 v58, v58
    v_sub_f32 v59, v59, v11
    v_exp_f32 v59, v59
    v_sub_f32 v60, v60, v11
    v_exp_f32 v60, v60
    v_sub_f32 v61, v61, v11
    v_exp_f32 v61, v61
    v_sub_f32 v62, v62, v11
    v_exp_f32 v62, v62
    v_sub_f32 v63, v63, v11
    v_exp_f32 v63, v63
    v_sub_f32 v64, v64, v11
    v_exp_f32 v64, v64
    v_sub_f32 v65, v65, v11
    v_exp_f32 v65, v65
    v_sub_f32 v66, v66, v11
    v_exp_f32 v66, v66
    v_sub_f32 v67, v67, v11
    v_exp_f32 v67, v67
    v_sub_f32 v68, v68, v11
    v_exp_f32 v68, v68
    v_sub_f32 v69, v69, v11
    v_exp_f32 v69, v69
    v_sub_f32 v70, v70, v11
    v_exp_f32 v70, v70
    v_sub_f32 v71, v71, v11
    v_exp_f32 v71, v71
    v_cvt_pk_bf16_f32 v72, v56, v57
    v_cvt_pk_bf16_f32 v73, v58, v59
    v_cvt_pk_bf16_f32 v74, v60, v61
    v_cvt_pk_bf16_f32 v75, v62, v63
    v_cvt_pk_bf16_f32 v76, v64, v65
    v_cvt_pk_bf16_f32 v77, v66, v67
    v_cvt_pk_bf16_f32 v78, v68, v69
    v_cvt_pk_bf16_f32 v79, v70, v71
    v_mul_f32 v80, v10, v80
    v_mul_f32 v81, v10, v81
    v_mul_f32 v82, v10, v82
    v_mul_f32 v83, v10, v83
    v_mul_f32 v84, v10, v84
    v_mul_f32 v85, v10, v85
    v_mul_f32 v86, v10, v86
    v_mul_f32 v87, v10, v87
    v_mul_f32 v88, v10, v88
    v_mul_f32 v89, v10, v89
    v_mul_f32 v90, v10, v90
    v_mul_f32 v91, v10, v91
    v_mul_f32 v92, v10, v92
    v_mul_f32 v93, v10, v93
    v_mul_f32 v94, v10, v94
    v_mul_f32 v95, v10, v95
    s_nop 1
    v_mfma_f32_32x32x16_bf16 v[80:95], v[120:123], v[72:75], v[80:95]
    v_mfma_f32_32x32x16_bf16 v[80:95], v[124:127], v[76:79], v[80:95]
    s_waitcnt vmcnt(4)
    s_barrier
    s_add_u32 s36, s26, 32768
    s_mov_b32 m0, s36
    s_add_u32 s37, s29, 4276224
    buffer_load_dwordx4 v4, s[8:11], s37 offen lds
    buffer_load_dwordx4 v4, s[8:11], s37 offen offset:1024 lds
    s_add_u32 s36, s26, 49152
    s_mov_b32 m0, s36
    s_add_u32 s37, s29, 8470528
    buffer_load_dwordx4 v4, s[8:11], s37 offen lds
    buffer_load_dwordx4 v4, s[8:11], s37 offen offset:1024 lds
    ds_read_b128 v[96:99], v6 offset:32768
    ds_read_b128 v[100:103], v6 offset:33792
    ds_read_b128 v[112:115], v6 offset:49152
    ds_read_b128 v[116:119], v6 offset:50176
    s_waitcnt lgkmcnt(0)
    v_mfma_f32_32x32x16_bf16 v[40:55], v[96:99], v[16:19], 0
    v_mfma_f32_32x32x16_bf16 v[40:55], v[100:103], v[20:23], v[40:55]
    s_nop 11
    v_max3_f32 v11, v40, v41, v42
    v_max3_f32 v11, v11, v43, v44
    v_max3_f32 v11, v11, v45, v46
    v_max3_f32 v11, v11, v47, v48
    v_max3_f32 v11, v11, v49, v50
    v_max3_f32 v11, v11, v51, v52
    v_max3_f32 v11, v11, v53, v54
    v_max_f32 v11, v11, v55
    v_mov_b32 v13, v11
    s_nop 1
    v_permlane32_swap_b32 v11, v13
    v_max_f32 v11, v11, v13
    v_max_f32 v11, v11, v12
    v_sub_f32 v10, v12, v11
    v_exp_f32 v10, v10
    v_mov_b32 v12, v11
    v_sub_f32 v40, v40, v11
    v_exp_f32 v40, v40
    v_sub_f32 v41, v41, v11
    v_exp_f32 v41, v41
    v_sub_f32 v42, v42, v11
    v_exp_f32 v42, v42
    v_sub_f32 v43, v43, v11
    v_exp_f32 v43, v43
    v_sub_f32 v44, v44, v11
    v_exp_f32 v44, v44
    v_sub_f32 v45, v45, v11
    v_exp_f32 v45, v45
    v_sub_f32 v46, v46, v11
    v_exp_f32 v46, v46
    v_sub_f32 v47, v47, v11
    v_exp_f32 v47, v47
    v_sub_f32 v48, v48, v11
    v_exp_f32 v48, v48
    v_sub_f32 v49, v49, v11
    v_exp_f32 v49, v49
    v_sub_f32 v50, v50, v11
    v_exp_f32 v50, v50
    v_sub_f32 v51, v51, v11
    v_exp_f32 v51, v51
    v_sub_f32 v52, v52, v11
    v_exp_f32 v52, v52
    v_sub_f32 v53, v53, v11
    v_exp_f32 v53, v53
    v_sub_f32 v54, v54, v11
    v_exp_f32 v54, v54
    v_sub_f32 v55, v55, v11
    v_exp_f32 v55, v55
    v_cvt_pk_bf16_f32 v72, v40, v41
    v_cvt_pk_bf16_f32 v73, v42, v43
    v_cvt_pk_bf16_f32 v74, v44, v45
    v_cvt_pk_bf16_f32 v75, v46, v47
    v_cvt_pk_bf16_f32 v76, v48, v49
    v_cvt_pk_bf16_f32 v77, v50, v51
    v_cvt_pk_bf16_f32 v78, v52, v53
    v_cvt_pk_bf16_f32 v79, v54, v55
    v_mul_f32 v80, v10, v80
    v_mul_f32 v81, v10, v81
    v_mul_f32 v82, v10, v82
    v_mul_f32 v83, v10, v83
    v_mul_f32 v84, v10, v84
    v_mul_f32 v85, v10, v85
    v_mul_f32 v86, v10, v86
    v_mul_f32 v87, v10, v87
    v_mul_f32 v88, v10, v88
    v_mul_f32 v89, v10, v89
    v_mul_f32 v90, v10, v90
    v_mul_f32 v91, v10, v91
    v_mul_f32 v92, v10, v92
    v_mul_f32 v93, v10, v93
    v_mul_f32 v94, v10, v94
    v_mul_f32 v95, v10, v95
    s_nop 1
    v_mfma_f32_32x32x16_bf16 v[80:95], v[112:115], v[72:75], v[80:95]
    v_mfma_f32_32x32x16_bf16 v[80:95], v[116:119], v[76:79], v[80:95]
    ds_read_b128 v[104:107], v6 offset:34816
    ds_read_b128 v[108:111], v6 offset:35840
    ds_read_b128 v[120:123], v6 offset:51200
    ds_read_b128 v[124:127], v6 offset:52224
    s_waitcnt lgkmcnt(0)
    v_mfma_f32_32x32x16_bf16 v[56:71], v[104:107], v[16:19], 0
    v_mfma_f32_32x32x16_bf16 v[56:71], v[108:111], v[20:23], v[56:71]
    s_nop 11
    v_max3_f32 v11, v56, v57, v58
    v_max3_f32 v11, v11, v59, v60
    v_max3_f32 v11, v11, v61, v62
    v_max3_f32 v11, v11, v63, v64
    v_max3_f32 v11, v11, v65, v66
    v_max3_f32 v11, v11, v67, v68
    v_max3_f32 v11, v11, v69, v70
    v_max_f32 v11, v11, v71
    v_mov_b32 v13, v11
    s_nop 1
    v_permlane32_swap_b32 v11, v13
    v_max_f32 v11, v11, v13
    v_max_f32 v11, v11, v12
    v_sub_f32 v10, v12, v11
    v_exp_f32 v10, v10
    v_mov_b32 v12, v11
    v_sub_f32 v56, v56, v11
    v_exp_f32 v56, v56
    v_sub_f32 v57, v57, v11
    v_exp_f32 v57, v57
    v_sub_f32 v58, v58, v11
    v_exp_f32 v58, v58
    v_sub_f32 v59, v59, v11
    v_exp_f32 v59, v59
    v_sub_f32 v60, v60, v11
    v_exp_f32 v60, v60
    v_sub_f32 v61, v61, v11
    v_exp_f32 v61, v61
    v_sub_f32 v62, v62, v11
    v_exp_f32 v62, v62
    v_sub_f32 v63, v63, v11
    v_exp_f32 v63, v63
    v_sub_f32 v64, v64, v11
    v_exp_f32 v64, v64
    v_sub_f32 v65, v65, v11
    v_exp_f32 v65, v65
    v_sub_f32 v66, v66, v11
    v_exp_f32 v66, v66
    v_sub_f32 v67, v67, v11
    v_exp_f32 v67, v67
    v_sub_f32 v68, v68, v11
    v_exp_f32 v68, v68
    v_sub_f32 v69, v69, v11
    v_exp_f32 v69, v69
    v_sub_f32 v70, v70, v11
    v_exp_f32 v70, v70
    v_sub_f32 v71, v71, v11
    v_exp_f32 v71, v71
    v_cvt_pk_bf16_f32 v72, v56, v57
    v_cvt_pk_bf16_f32 v73, v58, v59
    v_cvt_pk_bf16_f32 v74, v60, v61
    v_cvt_pk_bf16_f32 v75, v62, v63
    v_cvt_pk_bf16_f32 v76, v64, v65
    v_cvt_pk_bf16_f32 v77, v66, v67
    v_cvt_pk_bf16_f32 v78, v68, v69
    v_cvt_pk_bf16_f32 v79, v70, v71
    v_mul_f32 v80, v10, v80
    v_mul_f32 v81, v10, v81
    v_mul_f32 v82, v10, v82
    v_mul_f32 v83, v10, v83
    v_mul_f32 v84, v10, v84
    v_mul_f32 v85, v10, v85
    v_mul_f32 v86, v10, v86
    v_mul_f32 v87, v10, v87
    v_mul_f32 v88, v10, v88
    v_mul_f32 v89, v10, v89
    v_mul_f32 v90, v10, v90
    v_mul_f32 v91, v10, v91
    v_mul_f32 v92, v10, v92
    v_mul_f32 v93, v10, v93
    v_mul_f32 v94, v10, v94
    v_mul_f32 v95, v10, v95
    s_nop 1
    v_mfma_f32_32x32x16_bf16 v[80:95], v[120:123], v[72:75], v[80:95]
    v_mfma_f32_32x32x16_bf16 v[80:95], v[124:127], v[76:79], v[80:95]
    ds_read_b128 v[96:99], v6 offset:36864
    ds_read_b128 v[100:103], v6 offset:37888
    ds_read_b128 v[112:115], v6 offset:53248
    ds_read_b128 v[116:119], v6 offset:54272
    s_waitcnt lgkmcnt(0)
    v_mfma_f32_32x32x16_bf16 v[40:55], v[96:99], v[16:19], 0
    v_mfma_f32_32x32x16_bf16 v[40:55], v[100:103], v[20:23], v[40:55]
    s_nop 11
    v_max3_f32 v11, v40, v41, v42
    v_max3_f32 v11, v11, v43, v44
    v_max3_f32 v11, v11, v45, v46
    v_max3_f32 v11, v11, v47, v48
    v_max3_f32 v11, v11, v49, v50
    v_max3_f32 v11, v11, v51, v52
    v_max3_f32 v11, v11, v53, v54
    v_max_f32 v11, v11, v55
    v_mov_b32 v13, v11
    s_nop 1
    v_permlane32_swap_b32 v11, v13
    v_max_f32 v11, v11, v13
    v_max_f32 v11, v11, v12
    v_sub_f32 v10, v12, v11
    v_exp_f32 v10, v10
    v_mov_b32 v12, v11
    v_sub_f32 v40, v40, v11
    v_exp_f32 v40, v40
    v_sub_f32 v41, v41, v11
    v_exp_f32 v41, v41
    v_sub_f32 v42, v42, v11
    v_exp_f32 v42, v42
    v_sub_f32 v43, v43, v11
    v_exp_f32 v43, v43
    v_sub_f32 v44, v44, v11
    v_exp_f32 v44, v44
    v_sub_f32 v45, v45, v11
    v_exp_f32 v45, v45
    v_sub_f32 v46, v46, v11
    v_exp_f32 v46, v46
    v_sub_f32 v47, v47, v11
    v_exp_f32 v47, v47
    v_sub_f32 v48, v48, v11
    v_exp_f32 v48, v48
    v_sub_f32 v49, v49, v11
    v_exp_f32 v49, v49
    v_sub_f32 v50, v50, v11
    v_exp_f32 v50, v50
    v_sub_f32 v51, v51, v11
    v_exp_f32 v51, v51
    v_sub_f32 v52, v52, v11
    v_exp_f32 v52, v52
    v_sub_f32 v53, v53, v11
    v_exp_f32 v53, v53
    v_sub_f32 v54, v54, v11
    v_exp_f32 v54, v54
    v_sub_f32 v55, v55, v11
    v_exp_f32 v55, v55
    v_cvt_pk_bf16_f32 v72, v40, v41
    v_cvt_pk_bf16_f32 v73, v42, v43
    v_cvt_pk_bf16_f32 v74, v44, v45
    v_cvt_pk_bf16_f32 v75, v46, v47
    v_cvt_pk_bf16_f32 v76, v48, v49
    v_cvt_pk_bf16_f32 v77, v50, v51
    v_cvt_pk_bf16_f32 v78, v52, v53
    v_cvt_pk_bf16_f32 v79, v54, v55
    v_mul_f32 v80, v10, v80
    v_mul_f32 v81, v10, v81
    v_mul_f32 v82, v10, v82
    v_mul_f32 v83, v10, v83
    v_mul_f32 v84, v10, v84
    v_mul_f32 v85, v10, v85
    v_mul_f32 v86, v10, v86
    v_mul_f32 v87, v10, v87
    v_mul_f32 v88, v10, v88
    v_mul_f32 v89, v10, v89
    v_mul_f32 v90, v10, v90
    v_mul_f32 v91, v10, v91
    v_mul_f32 v92, v10, v92
    v_mul_f32 v93, v10, v93
    v_mul_f32 v94, v10, v94
    v_mul_f32 v95, v10, v95
    s_nop 1
    v_mfma_f32_32x32x16_bf16 v[80:95], v[112:115], v[72:75], v[80:95]
    v_mfma_f32_32x32x16_bf16 v[80:95], v[116:119], v[76:79], v[80:95]
    ds_read_b128 v[104:107], v6 offset:38912
    ds_read_b128 v[108:111], v6 offset:39936
    ds_read_b128 v[120:123], v6 offset:55296
    ds_read_b128 v[124:127], v6 offset:56320
    s_waitcnt lgkmcnt(0)
    v_mfma_f32_32x32x16_bf16 v[56:71], v[104:107], v[16:19], 0
    v_mfma_f32_32x32x16_bf16 v[56:71], v[108:111], v[20:23], v[56:71]
    s_nop 11
    v_max3_f32 v11, v56, v57, v58
    v_max3_f32 v11, v11, v59, v60
    v_max3_f32 v11, v11, v61, v62
    v_max3_f32 v11, v11, v63, v64
    v_max3_f32 v11, v11, v65, v66
    v_max3_f32 v11, v11, v67, v68
    v_max3_f32 v11, v11, v69, v70
    v_max_f32 v11, v11, v71
    v_mov_b32 v13, v11
    s_nop 1
    v_permlane32_swap_b32 v11, v13
    v_max_f32 v11, v11, v13
    v_max_f32 v11, v11, v12
    v_sub_f32 v10, v12, v11
    v_exp_f32 v10, v10
    v_mov_b32 v12, v11
    v_sub_f32 v56, v56, v11
    v_exp_f32 v56, v56
    v_sub_f32 v57, v57, v11
    v_exp_f32 v57, v57
    v_sub_f32 v58, v58, v11
    v_exp_f32 v58, v58
    v_sub_f32 v59, v59, v11
    v_exp_f32 v59, v59
    v_sub_f32 v60, v60, v11
    v_exp_f32 v60, v60
    v_sub_f32 v61, v61, v11
    v_exp_f32 v61, v61
    v_sub_f32 v62, v62, v11
    v_exp_f32 v62, v62
    v_sub_f32 v63, v63, v11
    v_exp_f32 v63, v63
    v_sub_f32 v64, v64, v11
    v_exp_f32 v64, v64
    v_sub_f32 v65, v65, v11
    v_exp_f32 v65, v65
    v_sub_f32 v66, v66, v11
    v_exp_f32 v66, v66
    v_sub_f32 v67, v67, v11
    v_exp_f32 v67, v67
    v_sub_f32 v68, v68, v11
    v_exp_f32 v68, v68
    v_sub_f32 v69, v69, v11
    v_exp_f32 v69, v69
    v_sub_f32 v70, v70, v11
    v_exp_f32 v70, v70
    v_sub_f32 v71, v71, v11
    v_exp_f32 v71, v71
    v_cvt_pk_bf16_f32 v72, v56, v57
    v_cvt_pk_bf16_f32 v73, v58, v59
    v_cvt_pk_bf16_f32 v74, v60, v61
    v_cvt_pk_bf16_f32 v75, v62, v63
    v_cvt_pk_bf16_f32 v76, v64, v65
    v_cvt_pk_bf16_f32 v77, v66, v67
    v_cvt_pk_bf16_f32 v78, v68, v69
    v_cvt_pk_bf16_f32 v79, v70, v71
    v_mul_f32 v80, v10, v80
    v_mul_f32 v81, v10, v81
    v_mul_f32 v82, v10, v82
    v_mul_f32 v83, v10, v83
    v_mul_f32 v84, v10, v84
    v_mul_f32 v85, v10, v85
    v_mul_f32 v86, v10, v86
    v_mul_f32 v87, v10, v87
    v_mul_f32 v88, v10, v88
    v_mul_f32 v89, v10, v89
    v_mul_f32 v90, v10, v90
    v_mul_f32 v91, v10, v91
    v_mul_f32 v92, v10, v92
    v_mul_f32 v93, v10, v93
    v_mul_f32 v94, v10, v94
    v_mul_f32 v95, v10, v95
    s_nop 1
    v_mfma_f32_32x32x16_bf16 v[80:95], v[120:123], v[72:75], v[80:95]
    v_mfma_f32_32x32x16_bf16 v[80:95], v[124:127], v[76:79], v[80:95]
    s_waitcnt vmcnt(4)
    s_barrier
    s_add_u32 s36, s26, 65536
    s_mov_b32 m0, s36
    s_add_u32 s37, s29, 4292608
    buffer_load_dwordx4 v4, s[8:11], s37 offen lds
    buffer_load_dwordx4 v4, s[8:11], s37 offen offset:1024 lds
    s_add_u32 s36, s26, 81920
    s_mov_b32 m0, s36
    s_add_u32 s37, s29, 8486912
    buffer_load_dwordx4 v4, s[8:11], s37 offen lds
    buffer_load_dwordx4 v4, s[8:11], s37 offen offset:1024 lds
    ds_read_b128 v[96:99], v5 offset:0
    ds_read_b128 v[100:103], v5 offset:1024
    ds_read_b128 v[112:115], v5 offset:16384
    ds_read_b128 v[116:119], v5 offset:17408
    s_waitcnt lgkmcnt(0)
    v_mfma_f32_32x32x16_bf16 v[40:55], v[96:99], v[16:19], 0
    v_mfma_f32_32x32x16_bf16 v[40:55], v[100:103], v[20:23], v[40:55]
    s_nop 11
    v_max3_f32 v11, v40, v41, v42
    v_max3_f32 v11, v11, v43, v44
    v_max3_f32 v11, v11, v45, v46
    v_max3_f32 v11, v11, v47, v48
    v_max3_f32 v11, v11, v49, v50
    v_max3_f32 v11, v11, v51, v52
    v_max3_f32 v11, v11, v53, v54
    v_max_f32 v11, v11, v55
    v_mov_b32 v13, v11
    s_nop 1
    v_permlane32_swap_b32 v11, v13
    v_max_f32 v11, v11, v13
    v_max_f32 v11, v11, v12
    v_sub_f32 v10, v12, v11
    v_exp_f32 v10, v10
    v_mov_b32 v12, v11
    v_sub_f32 v40, v40, v11
    v_exp_f32 v40, v40
    v_sub_f32 v41, v41, v11
    v_exp_f32 v41, v41
    v_sub_f32 v42, v42, v11
    v_exp_f32 v42, v42
    v_sub_f32 v43, v43, v11
    v_exp_f32 v43, v43
    v_sub_f32 v44, v44, v11
    v_exp_f32 v44, v44
    v_sub_f32 v45, v45, v11
    v_exp_f32 v45, v45
    v_sub_f32 v46, v46, v11
    v_exp_f32 v46, v46
    v_sub_f32 v47, v47, v11
    v_exp_f32 v47, v47
    v_sub_f32 v48, v48, v11
    v_exp_f32 v48, v48
    v_sub_f32 v49, v49, v11
    v_exp_f32 v49, v49
    v_sub_f32 v50, v50, v11
    v_exp_f32 v50, v50
    v_sub_f32 v51, v51, v11
    v_exp_f32 v51, v51
    v_sub_f32 v52, v52, v11
    v_exp_f32 v52, v52
    v_sub_f32 v53, v53, v11
    v_exp_f32 v53, v53
    v_sub_f32 v54, v54, v11
    v_exp_f32 v54, v54
    v_sub_f32 v55, v55, v11
    v_exp_f32 v55, v55
    v_cvt_pk_bf16_f32 v72, v40, v41
    v_cvt_pk_bf16_f32 v73, v42, v43
    v_cvt_pk_bf16_f32 v74, v44, v45
    v_cvt_pk_bf16_f32 v75, v46, v47
    v_cvt_pk_bf16_f32 v76, v48, v49
    v_cvt_pk_bf16_f32 v77, v50, v51
    v_cvt_pk_bf16_f32 v78, v52, v53
    v_cvt_pk_bf16_f32 v79, v54, v55
    v_mul_f32 v80, v10, v80
    v_mul_f32 v81, v10, v81
    v_mul_f32 v82, v10, v82
    v_mul_f32 v83, v10, v83
    v_mul_f32 v84, v10, v84
    v_mul_f32 v85, v10, v85
    v_mul_f32 v86, v10, v86
    v_mul_f32 v87, v10, v87
    v_mul_f32 v88, v10, v88
    v_mul_f32 v89, v10, v89
    v_mul_f32 v90, v10, v90
    v_mul_f32 v91, v10, v91
    v_mul_f32 v92, v10, v92
    v_mul_f32 v93, v10, v93
    v_mul_f32 v94, v10, v94
    v_mul_f32 v95, v10, v95
    s_nop 1
    v_mfma_f32_32x32x16_bf16 v[80:95], v[112:115], v[72:75], v[80:95]
    v_mfma_f32_32x32x16_bf16 v[80:95], v[116:119], v[76:79], v[80:95]
    ds_read_b128 v[104:107], v5 offset:2048
    ds_read_b128 v[108:111], v5 offset:3072
    ds_read_b128 v[120:123], v5 offset:18432
    ds_read_b128 v[124:127], v5 offset:19456
    s_waitcnt lgkmcnt(0)
    v_mfma_f32_32x32x16_bf16 v[56:71], v[104:107], v[16:19], 0
    v_mfma_f32_32x32x16_bf16 v[56:71], v[108:111], v[20:23], v[56:71]
    s_nop 11
    v_max3_f32 v11, v56, v57, v58
    v_max3_f32 v11, v11, v59, v60
    v_max3_f32 v11, v11, v61, v62
    v_max3_f32 v11, v11, v63, v64
    v_max3_f32 v11, v11, v65, v66
    v_max3_f32 v11, v11, v67, v68
    v_max3_f32 v11, v11, v69, v70
    v_max_f32 v11, v11, v71
    v_mov_b32 v13, v11
    s_nop 1
    v_permlane32_swap_b32 v11, v13
    v_max_f32 v11, v11, v13
    v_max_f32 v11, v11, v12
    v_sub_f32 v10, v12, v11
    v_exp_f32 v10, v10
    v_mov_b32 v12, v11
    v_sub_f32 v56, v56, v11
    v_exp_f32 v56, v56
    v_sub_f32 v57, v57, v11
    v_exp_f32 v57, v57
    v_sub_f32 v58, v58, v11
    v_exp_f32 v58, v58
    v_sub_f32 v59, v59, v11
    v_exp_f32 v59, v59
    v_sub_f32 v60, v60, v11
    v_exp_f32 v60, v60
    v_sub_f32 v61, v61, v11
    v_exp_f32 v61, v61
    v_sub_f32 v62, v62, v11
    v_exp_f32 v62, v62
    v_sub_f32 v63, v63, v11
    v_exp_f32 v63, v63
    v_sub_f32 v64, v64, v11
    v_exp_f32 v64, v64
    v_sub_f32 v65, v65, v11
    v_exp_f32 v65, v65
    v_sub_f32 v66, v66, v11
    v_exp_f32 v66, v66
    v_sub_f32 v67, v67, v11
    v_exp_f32 v67, v67
    v_sub_f32 v68, v68, v11
    v_exp_f32 v68, v68
    v_sub_f32 v69, v69, v11
    v_exp_f32 v69, v69
    v_sub_f32 v70, v70, v11
    v_exp_f32 v70, v70
    v_sub_f32 v71, v71, v11
    v_exp_f32 v71, v71
    v_cvt_pk_bf16_f32 v72, v56, v57
    v_cvt_pk_bf16_f32 v73, v58, v59
    v_cvt_pk_bf16_f32 v74, v60, v61
    v_cvt_pk_bf16_f32 v75, v62, v63
    v_cvt_pk_bf16_f32 v76, v64, v65
    v_cvt_pk_bf16_f32 v77, v66, v67
    v_cvt_pk_bf16_f32 v78, v68, v69
    v_cvt_pk_bf16_f32 v79, v70, v71
    v_mul_f32 v80, v10, v80
    v_mul_f32 v81, v10, v81
    v_mul_f32 v82, v10, v82
    v_mul_f32 v83, v10, v83
    v_mul_f32 v84, v10, v84
    v_mul_f32 v85, v10, v85
    v_mul_f32 v86, v10, v86
    v_mul_f32 v87, v10, v87
    v_mul_f32 v88, v10, v88
    v_mul_f32 v89, v10, v89
    v_mul_f32 v90, v10, v90
    v_mul_f32 v91, v10, v91
    v_mul_f32 v92, v10, v92
    v_mul_f32 v93, v10, v93
    v_mul_f32 v94, v10, v94
    v_mul_f32 v95, v10, v95
    s_nop 1
    v_mfma_f32_32x32x16_bf16 v[80:95], v[120:123], v[72:75], v[80:95]
    v_mfma_f32_32x32x16_bf16 v[80:95], v[124:127], v[76:79], v[80:95]
    ds_read_b128 v[96:99], v5 offset:4096
    ds_read_b128 v[100:103], v5 offset:5120
    ds_read_b128 v[112:115], v5 offset:20480
    ds_read_b128 v[116:119], v5 offset:21504
    s_waitcnt lgkmcnt(0)
    v_mfma_f32_32x32x16_bf16 v[40:55], v[96:99], v[16:19], 0
    v_mfma_f32_32x32x16_bf16 v[40:55], v[100:103], v[20:23], v[40:55]
    s_nop 11
    v_max3_f32 v11, v40, v41, v42
    v_max3_f32 v11, v11, v43, v44
    v_max3_f32 v11, v11, v45, v46
    v_max3_f32 v11, v11, v47, v48
    v_max3_f32 v11, v11, v49, v50
    v_max3_f32 v11, v11, v51, v52
    v_max3_f32 v11, v11, v53, v54
    v_max_f32 v11, v11, v55
    v_mov_b32 v13, v11
    s_nop 1
    v_permlane32_swap_b32 v11, v13
    v_max_f32 v11, v11, v13
    v_max_f32 v11, v11, v12
    v_sub_f32 v10, v12, v11
    v_exp_f32 v10, v10
    v_mov_b32 v12, v11
    v_sub_f32 v40, v40, v11
    v_exp_f32 v40, v40
    v_sub_f32 v41, v41, v11
    v_exp_f32 v41, v41
    v_sub_f32 v42, v42, v11
    v_exp_f32 v42, v42
    v_sub_f32 v43, v43, v11
    v_exp_f32 v43, v43
    v_sub_f32 v44, v44, v11
    v_exp_f32 v44, v44
    v_sub_f32 v45, v45, v11
    v_exp_f32 v45, v45
    v_sub_f32 v46, v46, v11
    v_exp_f32 v46, v46
    v_sub_f32 v47, v47, v11
    v_exp_f32 v47, v47
    v_sub_f32 v48, v48, v11
    v_exp_f32 v48, v48
    v_sub_f32 v49, v49, v11
    v_exp_f32 v49, v49
    v_sub_f32 v50, v50, v11
    v_exp_f32 v50, v50
    v_sub_f32 v51, v51, v11
    v_exp_f32 v51, v51
    v_sub_f32 v52, v52, v11
    v_exp_f32 v52, v52
    v_sub_f32 v53, v53, v11
    v_exp_f32 v53, v53
    v_sub_f32 v54, v54, v11
    v_exp_f32 v54, v54
    v_sub_f32 v55, v55, v11
    v_exp_f32 v55, v55
    v_cvt_pk_bf16_f32 v72, v40, v41
    v_cvt_pk_bf16_f32 v73, v42, v43
    v_cvt_pk_bf16_f32 v74, v44, v45
    v_cvt_pk_bf16_f32 v75, v46, v47
    v_cvt_pk_bf16_f32 v76, v48, v49
    v_cvt_pk_bf16_f32 v77, v50, v51
    v_cvt_pk_bf16_f32 v78, v52, v53
    v_cvt_pk_bf16_f32 v79, v54, v55
    v_mul_f32 v80, v10, v80
    v_mul_f32 v81, v10, v81
    v_mul_f32 v82, v10, v82
    v_mul_f32 v83, v10, v83
    v_mul_f32 v84, v10, v84
    v_mul_f32 v85, v10, v85
    v_mul_f32 v86, v10, v86
    v_mul_f32 v87, v10, v87
    v_mul_f32 v88, v10, v88
    v_mul_f32 v89, v10, v89
    v_mul_f32 v90, v10, v90
    v_mul_f32 v91, v10, v91
    v_mul_f32 v92, v10, v92
    v_mul_f32 v93, v10, v93
    v_mul_f32 v94, v10, v94
    v_mul_f32 v95, v10, v95
    s_nop 1
    v_mfma_f32_32x32x16_bf16 v[80:95], v[112:115], v[72:75], v[80:95]
    v_mfma_f32_32x32x16_bf16 v[80:95], v[116:119], v[76:79], v[80:95]
    ds_read_b128 v[104:107], v5 offset:6144
    ds_read_b128 v[108:111], v5 offset:7168
    ds_read_b128 v[120:123], v5 offset:22528
    ds_read_b128 v[124:127], v5 offset:23552
    s_waitcnt lgkmcnt(0)
    v_mfma_f32_32x32x16_bf16 v[56:71], v[104:107], v[16:19], 0
    v_mfma_f32_32x32x16_bf16 v[56:71], v[108:111], v[20:23], v[56:71]
    s_nop 11
    v_max3_f32 v11, v56, v57, v58
    v_max3_f32 v11, v11, v59, v60
    v_max3_f32 v11, v11, v61, v62
    v_max3_f32 v11, v11, v63, v64
    v_max3_f32 v11, v11, v65, v66
    v_max3_f32 v11, v11, v67, v68
    v_max3_f32 v11, v11, v69, v70
    v_max_f32 v11, v11, v71
    v_mov_b32 v13, v11
    s_nop 1
    v_permlane32_swap_b32 v11, v13
    v_max_f32 v11, v11, v13
    v_max_f32 v11, v11, v12
    v_sub_f32 v10, v12, v11
    v_exp_f32 v10, v10
    v_mov_b32 v12, v11
    v_sub_f32 v56, v56, v11
    v_exp_f32 v56, v56
    v_sub_f32 v57, v57, v11
    v_exp_f32 v57, v57
    v_sub_f32 v58, v58, v11
    v_exp_f32 v58, v58
    v_sub_f32 v59, v59, v11
    v_exp_f32 v59, v59
    v_sub_f32 v60, v60, v11
    v_exp_f32 v60, v60
    v_sub_f32 v61, v61, v11
    v_exp_f32 v61, v61
    v_sub_f32 v62, v62, v11
    v_exp_f32 v62, v62
    v_sub_f32 v63, v63, v11
    v_exp_f32 v63, v63
    v_sub_f32 v64, v64, v11
    v_exp_f32 v64, v64
    v_sub_f32 v65, v65, v11
    v_exp_f32 v65, v65
    v_sub_f32 v66, v66, v11
    v_exp_f32 v66, v66
    v_sub_f32 v67, v67, v11
    v_exp_f32 v67, v67
    v_sub_f32 v68, v68, v11
    v_exp_f32 v68, v68
    v_sub_f32 v69, v69, v11
    v_exp_f32 v69, v69
    v_sub_f32 v70, v70, v11
    v_exp_f32 v70, v70
    v_sub_f32 v71, v71, v11
    v_exp_f32 v71, v71
    v_cvt_pk_bf16_f32 v72, v56, v57
    v_cvt_pk_bf16_f32 v73, v58, v59
    v_cvt_pk_bf16_f32 v74, v60, v61
    v_cvt_pk_bf16_f32 v75, v62, v63
    v_cvt_pk_bf16_f32 v76, v64, v65
    v_cvt_pk_bf16_f32 v77, v66, v67
    v_cvt_pk_bf16_f32 v78, v68, v69
    v_cvt_pk_bf16_f32 v79, v70, v71
    v_mul_f32 v80, v10, v80
    v_mul_f32 v81, v10, v81
    v_mul_f32 v82, v10, v82
    v_mul_f32 v83, v10, v83
    v_mul_f32 v84, v10, v84
    v_mul_f32 v85, v10, v85
    v_mul_f32 v86, v10, v86
    v_mul_f32 v87, v10, v87
    v_mul_f32 v88, v10, v88
    v_mul_f32 v89, v10, v89
    v_mul_f32 v90, v10, v90
    v_mul_f32 v91, v10, v91
    v_mul_f32 v92, v10, v92
    v_mul_f32 v93, v10, v93
    v_mul_f32 v94, v10, v94
    v_mul_f32 v95, v10, v95
    s_nop 1
    v_mfma_f32_32x32x16_bf16 v[80:95], v[120:123], v[72:75], v[80:95]
    v_mfma_f32_32x32x16_bf16 v[80:95], v[124:127], v[76:79], v[80:95]
    s_waitcnt vmcnt(4)
    s_barrier
    s_add_u32 s36, s26, 98304
    s_mov_b32 m0, s36
    s_add_u32 s37, s29, 4308992
    buffer_load_dwordx4 v4, s[8:11], s37 offen lds
    buffer_load_dwordx4 v4, s[8:11], s37 offen offset:1024 lds
    s_add_u32 s36, s26, 114688
    s_mov_b32 m0, s36
    s_add_u32 s37, s29, 8503296
    buffer_load_dwordx4 v4, s[8:11], s37 offen lds
    buffer_load_dwordx4 v4, s[8:11], s37 offen offset:1024 lds
    ds_read_b128 v[96:99], v5 offset:32768
    ds_read_b128 v[100:103], v5 offset:33792
    ds_read_b128 v[112:115], v5 offset:49152
    ds_read_b128 v[116:119], v5 offset:50176
    s_waitcnt lgkmcnt(0)
    v_mfma_f32_32x32x16_bf16 v[40:55], v[96:99], v[16:19], 0
    v_mfma_f32_32x32x16_bf16 v[40:55], v[100:103], v[20:23], v[40:55]
    s_nop 11
    v_max3_f32 v11, v40, v41, v42
    v_max3_f32 v11, v11, v43, v44
    v_max3_f32 v11, v11, v45, v46
    v_max3_f32 v11, v11, v47, v48
    v_max3_f32 v11, v11, v49, v50
    v_max3_f32 v11, v11, v51, v52
    v_max3_f32 v11, v11, v53, v54
    v_max_f32 v11, v11, v55
    v_mov_b32 v13, v11
    s_nop 1
    v_permlane32_swap_b32 v11, v13
    v_max_f32 v11, v11, v13
    v_max_f32 v11, v11, v12
    v_sub_f32 v10, v12, v11
    v_exp_f32 v10, v10
    v_mov_b32 v12, v11
    v_sub_f32 v40, v40, v11
    v_exp_f32 v40, v40
    v_sub_f32 v41, v41, v11
    v_exp_f32 v41, v41
    v_sub_f32 v42, v42, v11
    v_exp_f32 v42, v42
    v_sub_f32 v43, v43, v11
    v_exp_f32 v43, v43
    v_sub_f32 v44, v44, v11
    v_exp_f32 v44, v44
    v_sub_f32 v45, v45, v11
    v_exp_f32 v45, v45
    v_sub_f32 v46, v46, v11
    v_exp_f32 v46, v46
    v_sub_f32 v47, v47, v11
    v_exp_f32 v47, v47
    v_sub_f32 v48, v48, v11
    v_exp_f32 v48, v48
    v_sub_f32 v49, v49, v11
    v_exp_f32 v49, v49
    v_sub_f32 v50, v50, v11
    v_exp_f32 v50, v50
    v_sub_f32 v51, v51, v11
    v_exp_f32 v51, v51
    v_sub_f32 v52, v52, v11
    v_exp_f32 v52, v52
    v_sub_f32 v53, v53, v11
    v_exp_f32 v53, v53
    v_sub_f32 v54, v54, v11
    v_exp_f32 v54, v54
    v_sub_f32 v55, v55, v11
    v_exp_f32 v55, v55
    v_cvt_pk_bf16_f32 v72, v40, v41
    v_cvt_pk_bf16_f32 v73, v42, v43
    v_cvt_pk_bf16_f32 v74, v44, v45
    v_cvt_pk_bf16_f32 v75, v46, v47
    v_cvt_pk_bf16_f32 v76, v48, v49
    v_cvt_pk_bf16_f32 v77, v50, v51
    v_cvt_pk_bf16_f32 v78, v52, v53
    v_cvt_pk_bf16_f32 v79, v54, v55
    v_mul_f32 v80, v10, v80
    v_mul_f32 v81, v10, v81
    v_mul_f32 v82, v10, v82
    v_mul_f32 v83, v10, v83
    v_mul_f32 v84, v10, v84
    v_mul_f32 v85, v10, v85
    v_mul_f32 v86, v10, v86
    v_mul_f32 v87, v10, v87
    v_mul_f32 v88, v10, v88
    v_mul_f32 v89, v10, v89
    v_mul_f32 v90, v10, v90
    v_mul_f32 v91, v10, v91
    v_mul_f32 v92, v10, v92
    v_mul_f32 v93, v10, v93
    v_mul_f32 v94, v10, v94
    v_mul_f32 v95, v10, v95
    s_nop 1
    v_mfma_f32_32x32x16_bf16 v[80:95], v[112:115], v[72:75], v[80:95]
    v_mfma_f32_32x32x16_bf16 v[80:95], v[116:119], v[76:79], v[80:95]
    ds_read_b128 v[104:107], v5 offset:34816
    ds_read_b128 v[108:111], v5 offset:35840
    ds_read_b128 v[120:123], v5 offset:51200
    ds_read_b128 v[124:127], v5 offset:52224
    s_waitcnt lgkmcnt(0)
    v_mfma_f32_32x32x16_bf16 v[56:71], v[104:107], v[16:19], 0
    v_mfma_f32_32x32x16_bf16 v[56:71], v[108:111], v[20:23], v[56:71]
    s_nop 11
    v_max3_f32 v11, v56, v57, v58
    v_max3_f32 v11, v11, v59, v60
    v_max3_f32 v11, v11, v61, v62
    v_max3_f32 v11, v11, v63, v64
    v_max3_f32 v11, v11, v65, v66
    v_max3_f32 v11, v11, v67, v68
    v_max3_f32 v11, v11, v69, v70
    v_max_f32 v11, v11, v71
    v_mov_b32 v13, v11
    s_nop 1
    v_permlane32_swap_b32 v11, v13
    v_max_f32 v11, v11, v13
    v_max_f32 v11, v11, v12
    v_sub_f32 v10, v12, v11
    v_exp_f32 v10, v10
    v_mov_b32 v12, v11
    v_sub_f32 v56, v56, v11
    v_exp_f32 v56, v56
    v_sub_f32 v57, v57, v11
    v_exp_f32 v57, v57
    v_sub_f32 v58, v58, v11
    v_exp_f32 v58, v58
    v_sub_f32 v59, v59, v11
    v_exp_f32 v59, v59
    v_sub_f32 v60, v60, v11
    v_exp_f32 v60, v60
    v_sub_f32 v61, v61, v11
    v_exp_f32 v61, v61
    v_sub_f32 v62, v62, v11
    v_exp_f32 v62, v62
    v_sub_f32 v63, v63, v11
    v_exp_f32 v63, v63
    v_sub_f32 v64, v64, v11
    v_exp_f32 v64, v64
    v_sub_f32 v65, v65, v11
    v_exp_f32 v65, v65
    v_sub_f32 v66, v66, v11
    v_exp_f32 v66, v66
    v_sub_f32 v67, v67, v11
    v_exp_f32 v67, v67
    v_sub_f32 v68, v68, v11
    v_exp_f32 v68, v68
    v_sub_f32 v69, v69, v11
    v_exp_f32 v69, v69
    v_sub_f32 v70, v70, v11
    v_exp_f32 v70, v70
    v_sub_f32 v71, v71, v11
    v_exp_f32 v71, v71
    v_cvt_pk_bf16_f32 v72, v56, v57
    v_cvt_pk_bf16_f32 v73, v58, v59
    v_cvt_pk_bf16_f32 v74, v60, v61
    v_cvt_pk_bf16_f32 v75, v62, v63
    v_cvt_pk_bf16_f32 v76, v64, v65
    v_cvt_pk_bf16_f32 v77, v66, v67
    v_cvt_pk_bf16_f32 v78, v68, v69
    v_cvt_pk_bf16_f32 v79, v70, v71
    v_mul_f32 v80, v10, v80
    v_mul_f32 v81, v10, v81
    v_mul_f32 v82, v10, v82
    v_mul_f32 v83, v10, v83
    v_mul_f32 v84, v10, v84
    v_mul_f32 v85, v10, v85
    v_mul_f32 v86, v10, v86
    v_mul_f32 v87, v10, v87
    v_mul_f32 v88, v10, v88
    v_mul_f32 v89, v10, v89
    v_mul_f32 v90, v10, v90
    v_mul_f32 v91, v10, v91
    v_mul_f32 v92, v10, v92
    v_mul_f32 v93, v10, v93
    v_mul_f32 v94, v10, v94
    v_mul_f32 v95, v10, v95
    s_nop 1
    v_mfma_f32_32x32x16_bf16 v[80:95], v[120:123], v[72:75], v[80:95]
    v_mfma_f32_32x32x16_bf16 v[80:95], v[124:127], v[76:79], v[80:95]
    ds_read_b128 v[96:99], v5 offset:36864
    ds_read_b128 v[100:103], v5 offset:37888
    ds_read_b128 v[112:115], v5 offset:53248
    ds_read_b128 v[116:119], v5 offset:54272
    s_waitcnt lgkmcnt(0)
    v_mfma_f32_32x32x16_bf16 v[40:55], v[96:99], v[16:19], 0
    v_mfma_f32_32x32x16_bf16 v[40:55], v[100:103], v[20:23], v[40:55]
    s_nop 11
    v_max3_f32 v11, v40, v41, v42
    v_max3_f32 v11, v11, v43, v44
    v_max3_f32 v11, v11, v45, v46
    v_max3_f32 v11, v11, v47, v48
    v_max3_f32 v11, v11, v49, v50
    v_max3_f32 v11, v11, v51, v52
    v_max3_f32 v11, v11, v53, v54
    v_max_f32 v11, v11, v55
    v_mov_b32 v13, v11
    s_nop 1
    v_permlane32_swap_b32 v11, v13
    v_max_f32 v11, v11, v13
    v_max_f32 v11, v11, v12
    v_sub_f32 v10, v12, v11
    v_exp_f32 v10, v10
    v_mov_b32 v12, v11
    v_sub_f32 v40, v40, v11
    v_exp_f32 v40, v40
    v_sub_f32 v41, v41, v11
    v_exp_f32 v41, v41
    v_sub_f32 v42, v42, v11
    v_exp_f32 v42, v42
    v_sub_f32 v43, v43, v11
    v_exp_f32 v43, v43
    v_sub_f32 v44, v44, v11
    v_exp_f32 v44, v44
    v_sub_f32 v45, v45, v11
    v_exp_f32 v45, v45
    v_sub_f32 v46, v46, v11
    v_exp_f32 v46, v46
    v_sub_f32 v47, v47, v11
    v_exp_f32 v47, v47
    v_sub_f32 v48, v48, v11
    v_exp_f32 v48, v48
    v_sub_f32 v49, v49, v11
    v_exp_f32 v49, v49
    v_sub_f32 v50, v50, v11
    v_exp_f32 v50, v50
    v_sub_f32 v51, v51, v11
    v_exp_f32 v51, v51
    v_sub_f32 v52, v52, v11
    v_exp_f32 v52, v52
    v_sub_f32 v53, v53, v11
    v_exp_f32 v53, v53
    v_sub_f32 v54, v54, v11
    v_exp_f32 v54, v54
    v_sub_f32 v55, v55, v11
    v_exp_f32 v55, v55
    v_cvt_pk_bf16_f32 v72, v40, v41
    v_cvt_pk_bf16_f32 v73, v42, v43
    v_cvt_pk_bf16_f32 v74, v44, v45
    v_cvt_pk_bf16_f32 v75, v46, v47
    v_cvt_pk_bf16_f32 v76, v48, v49
    v_cvt_pk_bf16_f32 v77, v50, v51
    v_cvt_pk_bf16_f32 v78, v52, v53
    v_cvt_pk_bf16_f32 v79, v54, v55
    v_mul_f32 v80, v10, v80
    v_mul_f32 v81, v10, v81
    v_mul_f32 v82, v10, v82
    v_mul_f32 v83, v10, v83
    v_mul_f32 v84, v10, v84
    v_mul_f32 v85, v10, v85
    v_mul_f32 v86, v10, v86
    v_mul_f32 v87, v10, v87
    v_mul_f32 v88, v10, v88
    v_mul_f32 v89, v10, v89
    v_mul_f32 v90, v10, v90
    v_mul_f32 v91, v10, v91
    v_mul_f32 v92, v10, v92
    v_mul_f32 v93, v10, v93
    v_mul_f32 v94, v10, v94
    v_mul_f32 v95, v10, v95
    s_nop 1
    v_mfma_f32_32x32x16_bf16 v[80:95], v[112:115], v[72:75], v[80:95]
    v_mfma_f32_32x32x16_bf16 v[80:95], v[116:119], v[76:79], v[80:95]
    ds_read_b128 v[104:107], v5 offset:38912
    ds_read_b128 v[108:111], v5 offset:39936
    ds_read_b128 v[120:123], v5 offset:55296
    ds_read_b128 v[124:127], v5 offset:56320
    s_waitcnt lgkmcnt(0)
    v_mfma_f32_32x32x16_bf16 v[56:71], v[104:107], v[16:19], 0
    v_mfma_f32_32x32x16_bf16 v[56:71], v[108:111], v[20:23], v[56:71]
    s_nop 11
    v_max3_f32 v11, v56, v57, v58
    v_max3_f32 v11, v11, v59, v60
    v_max3_f32 v11, v11, v61, v62
    v_max3_f32 v11, v11, v63, v64
    v_max3_f32 v11, v11, v65, v66
    v_max3_f32 v11, v11, v67, v68
    v_max3_f32 v11, v11, v69, v70
    v_max_f32 v11, v11, v71
    v_mov_b32 v13, v11
    s_nop 1
    v_permlane32_swap_b32 v11, v13
    v_max_f32 v11, v11, v13
    v_max_f32 v11, v11, v12
    v_sub_f32 v10, v12, v11
    v_exp_f32 v10, v10
    v_mov_b32 v12, v11
    v_sub_f32 v56, v56, v11
    v_exp_f32 v56, v56
    v_sub_f32 v57, v57, v11
    v_exp_f32 v57, v57
    v_sub_f32 v58, v58, v11
    v_exp_f32 v58, v58
    v_sub_f32 v59, v59, v11
    v_exp_f32 v59, v59
    v_sub_f32 v60, v60, v11
    v_exp_f32 v60, v60
    v_sub_f32 v61, v61, v11
    v_exp_f32 v61, v61
    v_sub_f32 v62, v62, v11
    v_exp_f32 v62, v62
    v_sub_f32 v63, v63, v11
    v_exp_f32 v63, v63
    v_sub_f32 v64, v64, v11
    v_exp_f32 v64, v64
    v_sub_f32 v65, v65, v11
    v_exp_f32 v65, v65
    v_sub_f32 v66, v66, v11
    v_exp_f32 v66, v66
    v_sub_f32 v67, v67, v11
    v_exp_f32 v67, v67
    v_sub_f32 v68, v68, v11
    v_exp_f32 v68, v68
    v_sub_f32 v69, v69, v11
    v_exp_f32 v69, v69
    v_sub_f32 v70, v70, v11
    v_exp_f32 v70, v70
    v_sub_f32 v71, v71, v11
    v_exp_f32 v71, v71
    v_cvt_pk_bf16_f32 v72, v56, v57
    v_cvt_pk_bf16_f32 v73, v58, v59
    v_cvt_pk_bf16_f32 v74, v60, v61
    v_cvt_pk_bf16_f32 v75, v62, v63
    v_cvt_pk_bf16_f32 v76, v64, v65
    v_cvt_pk_bf16_f32 v77, v66, v67
    v_cvt_pk_bf16_f32 v78, v68, v69
    v_cvt_pk_bf16_f32 v79, v70, v71
    v_mul_f32 v80, v10, v80
    v_mul_f32 v81, v10, v81
    v_mul_f32 v82, v10, v82
    v_mul_f32 v83, v10, v83
    v_mul_f32 v84, v10, v84
    v_mul_f32 v85, v10, v85
    v_mul_f32 v86, v10, v86
    v_mul_f32 v87, v10, v87
    v_mul_f32 v88, v10, v88
    v_mul_f32 v89, v10, v89
    v_mul_f32 v90, v10, v90
    v_mul_f32 v91, v10, v91
    v_mul_f32 v92, v10, v92
    v_mul_f32 v93, v10, v93
    v_mul_f32 v94, v10, v94
    v_mul_f32 v95, v10, v95
    s_nop 1
    v_mfma_f32_32x32x16_bf16 v[80:95], v[120:123], v[72:75], v[80:95]
    v_mfma_f32_32x32x16_bf16 v[80:95], v[124:127], v[76:79], v[80:95]
    s_waitcnt vmcnt(4)
    s_barrier
    ds_read_b128 v[96:99], v6 offset:0
    ds_read_b128 v[100:103], v6 offset:1024
    ds_read_b128 v[112:115], v6 offset:16384
    ds_read_b128 v[116:119], v6 offset:17408
    s_waitcnt lgkmcnt(0)
    v_mfma_f32_32x32x16_bf16 v[40:55], v[96:99], v[16:19], 0
    v_mfma_f32_32x32x16_bf16 v[40:55], v[100:103], v[20:23], v[40:55]
    s_nop 11
    v_max3_f32 v11, v40, v41, v42
    v_max3_f32 v11, v11, v43, v44
    v_max3_f32 v11, v11, v45, v46
    v_max3_f32 v11, v11, v47, v48
    v_max3_f32 v11, v11, v49, v50
    v_max3_f32 v11, v11, v51, v52
    v_max3_f32 v11, v11, v53, v54
    v_max_f32 v11, v11, v55
    v_mov_b32 v13, v11
    s_nop 1
    v_permlane32_swap_b32 v11, v13
    v_max_f32 v11, v11, v13
    v_max_f32 v11, v11, v12
    v_sub_f32 v10, v12, v11
    v_exp_f32 v10, v10
    v_mov_b32 v12, v11
    v_sub_f32 v40, v40, v11
    v_exp_f32 v40, v40
    v_sub_f32 v41, v41, v11
    v_exp_f32 v41, v41
    v_sub_f32 v42, v42, v11
    v_exp_f32 v42, v42
    v_sub_f32 v43, v43, v11
    v_exp_f32 v43, v43
    v_sub_f32 v44, v44, v11
    v_exp_f32 v44, v44
    v_sub_f32 v45, v45, v11
    v_exp_f32 v45, v45
    v_sub_f32 v46, v46, v11
    v_exp_f32 v46, v46
    v_sub_f32 v47, v47, v11
    v_exp_f32 v47, v47
    v_sub_f32 v48, v48, v11
    v_exp_f32 v48, v48
    v_sub_f32 v49, v49, v11
    v_exp_f32 v49, v49
    v_sub_f32 v50, v50, v11
    v_exp_f32 v50, v50
    v_sub_f32 v51, v51, v11
    v_exp_f32 v51, v51
    v_sub_f32 v52, v52, v11
    v_exp_f32 v52, v52
    v_sub_f32 v53, v53, v11
    v_exp_f32 v53, v53
    v_sub_f32 v54, v54, v11
    v_exp_f32 v54, v54
    v_sub_f32 v55, v55, v11
    v_exp_f32 v55, v55
    v_cvt_pk_bf16_f32 v72, v40, v41
    v_cvt_pk_bf16_f32 v73, v42, v43
    v_cvt_pk_bf16_f32 v74, v44, v45
    v_cvt_pk_bf16_f32 v75, v46, v47
    v_cvt_pk_bf16_f32 v76, v48, v49
    v_cvt_pk_bf16_f32 v77, v50, v51
    v_cvt_pk_bf16_f32 v78, v52, v53
    v_cvt_pk_bf16_f32 v79, v54, v55
    v_mul_f32 v80, v10, v80
    v_mul_f32 v81, v10, v81
    v_mul_f32 v82, v10, v82
    v_mul_f32 v83, v10, v83
    v_mul_f32 v84, v10, v84
    v_mul_f32 v85, v10, v85
    v_mul_f32 v86, v10, v86
    v_mul_f32 v87, v10, v87
    v_mul_f32 v88, v10, v88
    v_mul_f32 v89, v10, v89
    v_mul_f32 v90, v10, v90
    v_mul_f32 v91, v10, v91
    v_mul_f32 v92, v10, v92
    v_mul_f32 v93, v10, v93
    v_mul_f32 v94, v10, v94
    v_mul_f32 v95, v10, v95
    s_nop 1
    v_mfma_f32_32x32x16_bf16 v[80:95], v[112:115], v[72:75], v[80:95]
    v_mfma_f32_32x32x16_bf16 v[80:95], v[116:119], v[76:79], v[80:95]
    ds_read_b128 v[104:107], v6 offset:2048
    ds_read_b128 v[108:111], v6 offset:3072
    ds_read_b128 v[120:123], v6 offset:18432
    ds_read_b128 v[124:127], v6 offset:19456
    s_waitcnt lgkmcnt(0)
    v_mfma_f32_32x32x16_bf16 v[56:71], v[104:107], v[16:19], 0
    v_mfma_f32_32x32x16_bf16 v[56:71], v[108:111], v[20:23], v[56:71]
    s_nop 11
    v_max3_f32 v11, v56, v57, v58
    v_max3_f32 v11, v11, v59, v60
    v_max3_f32 v11, v11, v61, v62
    v_max3_f32 v11, v11, v63, v64
    v_max3_f32 v11, v11, v65, v66
    v_max3_f32 v11, v11, v67, v68
    v_max3_f32 v11, v11, v69, v70
    v_max_f32 v11, v11, v71
    v_mov_b32 v13, v11
    s_nop 1
    v_permlane32_swap_b32 v11, v13
    v_max_f32 v11, v11, v13
    v_max_f32 v11, v11, v12
    v_sub_f32 v10, v12, v11
    v_exp_f32 v10, v10
    v_mov_b32 v12, v11
    v_sub_f32 v56, v56, v11
    v_exp_f32 v56, v56
    v_sub_f32 v57, v57, v11
    v_exp_f32 v57, v57
    v_sub_f32 v58, v58, v11
    v_exp_f32 v58, v58
    v_sub_f32 v59, v59, v11
    v_exp_f32 v59, v59
    v_sub_f32 v60, v60, v11
    v_exp_f32 v60, v60
    v_sub_f32 v61, v61, v11
    v_exp_f32 v61, v61
    v_sub_f32 v62, v62, v11
    v_exp_f32 v62, v62
    v_sub_f32 v63, v63, v11
    v_exp_f32 v63, v63
    v_sub_f32 v64, v64, v11
    v_exp_f32 v64, v64
    v_sub_f32 v65, v65, v11
    v_exp_f32 v65, v65
    v_sub_f32 v66, v66, v11
    v_exp_f32 v66, v66
    v_sub_f32 v67, v67, v11
    v_exp_f32 v67, v67
    v_sub_f32 v68, v68, v11
    v_exp_f32 v68, v68
    v_sub_f32 v69, v69, v11
    v_exp_f32 v69, v69
    v_sub_f32 v70, v70, v11
    v_exp_f32 v70, v70
    v_sub_f32 v71, v71, v11
    v_exp_f32 v71, v71
    v_cvt_pk_bf16_f32 v72, v56, v57
    v_cvt_pk_bf16_f32 v73, v58, v59
    v_cvt_pk_bf16_f32 v74, v60, v61
    v_cvt_pk_bf16_f32 v75, v62, v63
    v_cvt_pk_bf16_f32 v76, v64, v65
    v_cvt_pk_bf16_f32 v77, v66, v67
    v_cvt_pk_bf16_f32 v78, v68, v69
    v_cvt_pk_bf16_f32 v79, v70, v71
    v_mul_f32 v80, v10, v80
    v_mul_f32 v81, v10, v81
    v_mul_f32 v82, v10, v82
    v_mul_f32 v83, v10, v83
    v_mul_f32 v84, v10, v84
    v_mul_f32 v85, v10, v85
    v_mul_f32 v86, v10, v86
    v_mul_f32 v87, v10, v87
    v_mul_f32 v88, v10, v88
    v_mul_f32 v89, v10, v89
    v_mul_f32 v90, v10, v90
    v_mul_f32 v91, v10, v91
    v_mul_f32 v92, v10, v92
    v_mul_f32 v93, v10, v93
    v_mul_f32 v94, v10, v94
    v_mul_f32 v95, v10, v95
    s_nop 1
    v_mfma_f32_32x32x16_bf16 v[80:95], v[120:123], v[72:75], v[80:95]
    v_mfma_f32_32x32x16_bf16 v[80:95], v[124:127], v[76:79], v[80:95]
    ds_read_b128 v[96:99], v6 offset:4096
    ds_read_b128 v[100:103], v6 offset:5120
    ds_read_b128 v[112:115], v6 offset:20480
    ds_read_b128 v[116:119], v6 offset:21504
    s_waitcnt lgkmcnt(0)
    v_mfma_f32_32x32x16_bf16 v[40:55], v[96:99], v[16:19], 0
    v_mfma_f32_32x32x16_bf16 v[40:55], v[100:103], v[20:23], v[40:55]
    s_nop 11
    v_max3_f32 v11, v40, v41, v42
    v_max3_f32 v11, v11, v43, v44
    v_max3_f32 v11, v11, v45, v46
    v_max3_f32 v11, v11, v47, v48
    v_max3_f32 v11, v11, v49, v50
    v_max3_f32 v11, v11, v51, v52
    v_max3_f32 v11, v11, v53, v54
    v_max_f32 v11, v11, v55
    v_mov_b32 v13, v11
    s_nop 1
    v_permlane32_swap_b32 v11, v13
    v_max_f32 v11, v11, v13
    v_max_f32 v11, v11, v12
    v_sub_f32 v10, v12, v11
    v_exp_f32 v10, v10
    v_mov_b32 v12, v11
    v_sub_f32 v40, v40, v11
    v_exp_f32 v40, v40
    v_sub_f32 v41, v41, v11
    v_exp_f32 v41, v41
    v_sub_f32 v42, v42, v11
    v_exp_f32 v42, v42
    v_sub_f32 v43, v43, v11
    v_exp_f32 v43, v43
    v_sub_f32 v44, v44, v11
    v_exp_f32 v44, v44
    v_sub_f32 v45, v45, v11
    v_exp_f32 v45, v45
    v_sub_f32 v46, v46, v11
    v_exp_f32 v46, v46
    v_sub_f32 v47, v47, v11
    v_exp_f32 v47, v47
    v_sub_f32 v48, v48, v11
    v_exp_f32 v48, v48
    v_sub_f32 v49, v49, v11
    v_exp_f32 v49, v49
    v_sub_f32 v50, v50, v11
    v_exp_f32 v50, v50
    v_sub_f32 v51, v51, v11
    v_exp_f32 v51, v51
    v_sub_f32 v52, v52, v11
    v_exp_f32 v52, v52
    v_sub_f32 v53, v53, v11
    v_exp_f32 v53, v53
    v_sub_f32 v54, v54, v11
    v_exp_f32 v54, v54
    v_sub_f32 v55, v55, v11
    v_exp_f32 v55, v55
    v_cvt_pk_bf16_f32 v72, v40, v41
    v_cvt_pk_bf16_f32 v73, v42, v43
    v_cvt_pk_bf16_f32 v74, v44, v45
    v_cvt_pk_bf16_f32 v75, v46, v47
    v_cvt_pk_bf16_f32 v76, v48, v49
    v_cvt_pk_bf16_f32 v77, v50, v51
    v_cvt_pk_bf16_f32 v78, v52, v53
    v_cvt_pk_bf16_f32 v79, v54, v55
    v_mul_f32 v80, v10, v80
    v_mul_f32 v81, v10, v81
    v_mul_f32 v82, v10, v82
    v_mul_f32 v83, v10, v83
    v_mul_f32 v84, v10, v84
    v_mul_f32 v85, v10, v85
    v_mul_f32 v86, v10, v86
    v_mul_f32 v87, v10, v87
    v_mul_f32 v88, v10, v88
    v_mul_f32 v89, v10, v89
    v_mul_f32 v90, v10, v90
    v_mul_f32 v91, v10, v91
    v_mul_f32 v92, v10, v92
    v_mul_f32 v93, v10, v93
    v_mul_f32 v94, v10, v94
    v_mul_f32 v95, v10, v95
    s_nop 1
    v_mfma_f32_32x32x16_bf16 v[80:95], v[112:115], v[72:75], v[80:95]
    v_mfma_f32_32x32x16_bf16 v[80:95], v[116:119], v[76:79], v[80:95]
    ds_read_b128 v[104:107], v6 offset:6144
    ds_read_b128 v[108:111], v6 offset:7168
    ds_read_b128 v[120:123], v6 offset:22528
    ds_read_b128 v[124:127], v6 offset:23552
    s_waitcnt lgkmcnt(0)
    v_mfma_f32_32x32x16_bf16 v[56:71], v[104:107], v[16:19], 0
    v_mfma_f32_32x32x16_bf16 v[56:71], v[108:111], v[20:23], v[56:71]
    s_nop 11
    v_max3_f32 v11, v56, v57, v58
    v_max3_f32 v11, v11, v59, v60
    v_max3_f32 v11, v11, v61, v62
    v_max3_f32 v11, v11, v63, v64
    v_max3_f32 v11, v11, v65, v66
    v_max3_f32 v11, v11, v67, v68
    v_max3_f32 v11, v11, v69, v70
    v_max_f32 v11, v11, v71
    v_mov_b32 v13, v11
    s_nop 1
    v_permlane32_swap_b32 v11, v13
    v_max_f32 v11, v11, v13
    v_max_f32 v11, v11, v12
    v_sub_f32 v10, v12, v11
    v_exp_f32 v10, v10
    v_mov_b32 v12, v11
    v_sub_f32 v56, v56, v11
    v_exp_f32 v56, v56
    v_sub_f32 v57, v57, v11
    v_exp_f32 v57, v57
    v_sub_f32 v58, v58, v11
    v_exp_f32 v58, v58
    v_sub_f32 v59, v59, v11
    v_exp_f32 v59, v59
    v_sub_f32 v60, v60, v11
    v_exp_f32 v60, v60
    v_sub_f32 v61, v61, v11
    v_exp_f32 v61, v61
    v_sub_f32 v62, v62, v11
    v_exp_f32 v62, v62
    v_sub_f32 v63, v63, v11
    v_exp_f32 v63, v63
    v_sub_f32 v64, v64, v11
    v_exp_f32 v64, v64
    v_sub_f32 v65, v65, v11
    v_exp_f32 v65, v65
    v_sub_f32 v66, v66, v11
    v_exp_f32 v66, v66
    v_sub_f32 v67, v67, v11
    v_exp_f32 v67, v67
    v_sub_f32 v68, v68, v11
    v_exp_f32 v68, v68
    v_sub_f32 v69, v69, v11
    v_exp_f32 v69, v69
    v_sub_f32 v70, v70, v11
    v_exp_f32 v70, v70
    v_sub_f32 v71, v71, v11
    v_exp_f32 v71, v71
    v_cvt_pk_bf16_f32 v72, v56, v57
    v_cvt_pk_bf16_f32 v73, v58, v59
    v_cvt_pk_bf16_f32 v74, v60, v61
    v_cvt_pk_bf16_f32 v75, v62, v63
    v_cvt_pk_bf16_f32 v76, v64, v65
    v_cvt_pk_bf16_f32 v77, v66, v67
    v_cvt_pk_bf16_f32 v78, v68, v69
    v_cvt_pk_bf16_f32 v79, v70, v71
    v_mul_f32 v80, v10, v80
    v_mul_f32 v81, v10, v81
    v_mul_f32 v82, v10, v82
    v_mul_f32 v83, v10, v83
    v_mul_f32 v84, v10, v84
    v_mul_f32 v85, v10, v85
    v_mul_f32 v86, v10, v86
    v_mul_f32 v87, v10, v87
    v_mul_f32 v88, v10, v88
    v_mul_f32 v89, v10, v89
    v_mul_f32 v90, v10, v90
    v_mul_f32 v91, v10, v91
    v_mul_f32 v92, v10, v92
    v_mul_f32 v93, v10, v93
    v_mul_f32 v94, v10, v94
    v_mul_f32 v95, v10, v95
    s_nop 1
    v_mfma_f32_32x32x16_bf16 v[80:95], v[120:123], v[72:75], v[80:95]
    v_mfma_f32_32x32x16_bf16 v[80:95], v[124:127], v[76:79], v[80:95]
    s_waitcnt vmcnt(0)
    s_barrier
    ds_read_b128 v[96:99], v6 offset:32768
    ds_read_b128 v[100:103], v6 offset:33792
    ds_read_b128 v[112:115], v6 offset:49152
    ds_read_b128 v[116:119], v6 offset:50176
    s_waitcnt lgkmcnt(0)
    v_mfma_f32_32x32x16_bf16 v[40:55], v[96:99], v[16:19], 0
    v_mfma_f32_32x32x16_bf16 v[40:55], v[100:103], v[20:23], v[40:55]
    s_nop 11
    v_max3_f32 v11, v40, v41, v42
    v_max3_f32 v11, v11, v43, v44
    v_max3_f32 v11, v11, v45, v46
    v_max3_f32 v11, v11, v47, v48
    v_max3_f32 v11, v11, v49, v50
    v_max3_f32 v11, v11, v51, v52
    v_max3_f32 v11, v11, v53, v54
    v_max_f32 v11, v11, v55
    v_mov_b32 v13, v11
    s_nop 1
    v_permlane32_swap_b32 v11, v13
    v_max_f32 v11, v11, v13
    v_max_f32 v11, v11, v12
    v_sub_f32 v10, v12, v11
    v_exp_f32 v10, v10
    v_mov_b32 v12, v11
    v_sub_f32 v40, v40, v11
    v_exp_f32 v40, v40
    v_sub_f32 v41, v41, v11
    v_exp_f32 v41, v41
    v_sub_f32 v42, v42, v11
    v_exp_f32 v42, v42
    v_sub_f32 v43, v43, v11
    v_exp_f32 v43, v43
    v_sub_f32 v44, v44, v11
    v_exp_f32 v44, v44
    v_sub_f32 v45, v45, v11
    v_exp_f32 v45, v45
    v_sub_f32 v46, v46, v11
    v_exp_f32 v46, v46
    v_sub_f32 v47, v47, v11
    v_exp_f32 v47, v47
    v_sub_f32 v48, v48, v11
    v_exp_f32 v48, v48
    v_sub_f32 v49, v49, v11
    v_exp_f32 v49, v49
    v_sub_f32 v50, v50, v11
    v_exp_f32 v50, v50
    v_sub_f32 v51, v51, v11
    v_exp_f32 v51, v51
    v_sub_f32 v52, v52, v11
    v_exp_f32 v52, v52
    v_sub_f32 v53, v53, v11
    v_exp_f32 v53, v53
    v_sub_f32 v54, v54, v11
    v_exp_f32 v54, v54
    v_sub_f32 v55, v55, v11
    v_exp_f32 v55, v55
    v_cvt_pk_bf16_f32 v72, v40, v41
    v_cvt_pk_bf16_f32 v73, v42, v43
    v_cvt_pk_bf16_f32 v74, v44, v45
    v_cvt_pk_bf16_f32 v75, v46, v47
    v_cvt_pk_bf16_f32 v76, v48, v49
    v_cvt_pk_bf16_f32 v77, v50, v51
    v_cvt_pk_bf16_f32 v78, v52, v53
    v_cvt_pk_bf16_f32 v79, v54, v55
    v_mul_f32 v80, v10, v80
    v_mul_f32 v81, v10, v81
    v_mul_f32 v82, v10, v82
    v_mul_f32 v83, v10, v83
    v_mul_f32 v84, v10, v84
    v_mul_f32 v85, v10, v85
    v_mul_f32 v86, v10, v86
    v_mul_f32 v87, v10, v87
    v_mul_f32 v88, v10, v88
    v_mul_f32 v89, v10, v89
    v_mul_f32 v90, v10, v90
    v_mul_f32 v91, v10, v91
    v_mul_f32 v92, v10, v92
    v_mul_f32 v93, v10, v93
    v_mul_f32 v94, v10, v94
    v_mul_f32 v95, v10, v95
    s_nop 1
    v_mfma_f32_32x32x16_bf16 v[80:95], v[112:115], v[72:75], v[80:95]
    v_mfma_f32_32x32x16_bf16 v[80:95], v[116:119], v[76:79], v[80:95]
    ds_read_b128 v[104:107], v6 offset:34816
    ds_read_b128 v[108:111], v6 offset:35840
    ds_read_b128 v[120:123], v6 offset:51200
    ds_read_b128 v[124:127], v6 offset:52224
    s_waitcnt lgkmcnt(0)
    v_mfma_f32_32x32x16_bf16 v[56:71], v[104:107], v[16:19], 0
    v_mfma_f32_32x32x16_bf16 v[56:71], v[108:111], v[20:23], v[56:71]
    s_nop 11
    v_max3_f32 v11, v56, v57, v58
    v_max3_f32 v11, v11, v59, v60
    v_max3_f32 v11, v11, v61, v62
    v_max3_f32 v11, v11, v63, v64
    v_max3_f32 v11, v11, v65, v66
    v_max3_f32 v11, v11, v67, v68
    v_max3_f32 v11, v11, v69, v70
    v_max_f32 v11, v11, v71
    v_mov_b32 v13, v11
    s_nop 1
    v_permlane32_swap_b32 v11, v13
    v_max_f32 v11, v11, v13
    v_max_f32 v11, v11, v12
    v_sub_f32 v10, v12, v11
    v_exp_f32 v10, v10
    v_mov_b32 v12, v11
    v_sub_f32 v56, v56, v11
    v_exp_f32 v56, v56
    v_sub_f32 v57, v57, v11
    v_exp_f32 v57, v57
    v_sub_f32 v58, v58, v11
    v_exp_f32 v58, v58
    v_sub_f32 v59, v59, v11
    v_exp_f32 v59, v59
    v_sub_f32 v60, v60, v11
    v_exp_f32 v60, v60
    v_sub_f32 v61, v61, v11
    v_exp_f32 v61, v61
    v_sub_f32 v62, v62, v11
    v_exp_f32 v62, v62
    v_sub_f32 v63, v63, v11
    v_exp_f32 v63, v63
    v_sub_f32 v64, v64, v11
    v_exp_f32 v64, v64
    v_sub_f32 v65, v65, v11
    v_exp_f32 v65, v65
    v_sub_f32 v66, v66, v11
    v_exp_f32 v66, v66
    v_sub_f32 v67, v67, v11
    v_exp_f32 v67, v67
    v_sub_f32 v68, v68, v11
    v_exp_f32 v68, v68
    v_sub_f32 v69, v69, v11
    v_exp_f32 v69, v69
    v_sub_f32 v70, v70, v11
    v_exp_f32 v70, v70
    v_sub_f32 v71, v71, v11
    v_exp_f32 v71, v71
    v_cvt_pk_bf16_f32 v72, v56, v57
    v_cvt_pk_bf16_f32 v73, v58, v59
    v_cvt_pk_bf16_f32 v74, v60, v61
    v_cvt_pk_bf16_f32 v75, v62, v63
    v_cvt_pk_bf16_f32 v76, v64, v65
    v_cvt_pk_bf16_f32 v77, v66, v67
    v_cvt_pk_bf16_f32 v78, v68, v69
    v_cvt_pk_bf16_f32 v79, v70, v71
    v_mul_f32 v80, v10, v80
    v_mul_f32 v81, v10, v81
    v_mul_f32 v82, v10, v82
    v_mul_f32 v83, v10, v83
    v_mul_f32 v84, v10, v84
    v_mul_f32 v85, v10, v85
    v_mul_f32 v86, v10, v86
    v_mul_f32 v87, v10, v87
    v_mul_f32 v88, v10, v88
    v_mul_f32 v89, v10, v89
    v_mul_f32 v90, v10, v90
    v_mul_f32 v91, v10, v91
    v_mul_f32 v92, v10, v92
    v_mul_f32 v93, v10, v93
    v_mul_f32 v94, v10, v94
    v_mul_f32 v95, v10, v95
    s_nop 1
    v_mfma_f32_32x32x16_bf16 v[80:95], v[120:123], v[72:75], v[80:95]
    v_mfma_f32_32x32x16_bf16 v[80:95], v[124:127], v[76:79], v[80:95]
    ds_read_b128 v[96:99], v6 offset:36864
    ds_read_b128 v[100:103], v6 offset:37888
    ds_read_b128 v[112:115], v6 offset:53248
    ds_read_b128 v[116:119], v6 offset:54272
    s_waitcnt lgkmcnt(0)
    v_mfma_f32_32x32x16_bf16 v[40:55], v[96:99], v[16:19], 0
    v_mfma_f32_32x32x16_bf16 v[40:55], v[100:103], v[20:23], v[40:55]
    s_nop 11
    v_max3_f32 v11, v40, v41, v42
    v_max3_f32 v11, v11, v43, v44
    v_max3_f32 v11, v11, v45, v46
    v_max3_f32 v11, v11, v47, v48
    v_max3_f32 v11, v11, v49, v50
    v_max3_f32 v11, v11, v51, v52
    v_max3_f32 v11, v11, v53, v54
    v_max_f32 v11, v11, v55
    v_mov_b32 v13, v11
    s_nop 1
    v_permlane32_swap_b32 v11, v13
    v_max_f32 v11, v11, v13
    v_max_f32 v11, v11, v12
    v_sub_f32 v10, v12, v11
    v_exp_f32 v10, v10
    v_mov_b32 v12, v11
    v_sub_f32 v40, v40, v11
    v_exp_f32 v40, v40
    v_sub_f32 v41, v41, v11
    v_exp_f32 v41, v41
    v_sub_f32 v42, v42, v11
    v_exp_f32 v42, v42
    v_sub_f32 v43, v43, v11
    v_exp_f32 v43, v43
    v_sub_f32 v44, v44, v11
    v_exp_f32 v44, v44
    v_sub_f32 v45, v45, v11
    v_exp_f32 v45, v45
    v_sub_f32 v46, v46, v11
    v_exp_f32 v46, v46
    v_sub_f32 v47, v47, v11
    v_exp_f32 v47, v47
    v_sub_f32 v48, v48, v11
    v_exp_f32 v48, v48
    v_sub_f32 v49, v49, v11
    v_exp_f32 v49, v49
    v_sub_f32 v50, v50, v11
    v_exp_f32 v50, v50
    v_sub_f32 v51, v51, v11
    v_exp_f32 v51, v51
    v_sub_f32 v52, v52, v11
    v_exp_f32 v52, v52
    v_sub_f32 v53, v53, v11
    v_exp_f32 v53, v53
    v_sub_f32 v54, v54, v11
    v_exp_f32 v54, v54
    v_sub_f32 v55, v55, v11
    v_exp_f32 v55, v55
    v_cvt_pk_bf16_f32 v72, v40, v41
    v_cvt_pk_bf16_f32 v73, v42, v43
    v_cvt_pk_bf16_f32 v74, v44, v45
    v_cvt_pk_bf16_f32 v75, v46, v47
    v_cvt_pk_bf16_f32 v76, v48, v49
    v_cvt_pk_bf16_f32 v77, v50, v51
    v_cvt_pk_bf16_f32 v78, v52, v53
    v_cvt_pk_bf16_f32 v79, v54, v55
    v_mul_f32 v80, v10, v80
    v_mul_f32 v81, v10, v81
    v_mul_f32 v82, v10, v82
    v_mul_f32 v83, v10, v83
    v_mul_f32 v84, v10, v84
    v_mul_f32 v85, v10, v85
    v_mul_f32 v86, v10, v86
    v_mul_f32 v87, v10, v87
    v_mul_f32 v88, v10, v88
    v_mul_f32 v89, v10, v89
    v_mul_f32 v90, v10, v90
    v_mul_f32 v91, v10, v91
    v_mul_f32 v92, v10, v92
    v_mul_f32 v93, v10, v93
    v_mul_f32 v94, v10, v94
    v_mul_f32 v95, v10, v95
    s_nop 1
    v_mfma_f32_32x32x16_bf16 v[80:95], v[112:115], v[72:75], v[80:95]
    v_mfma_f32_32x32x16_bf16 v[80:95], v[116:119], v[76:79], v[80:95]
    ds_read_b128 v[104:107], v6 offset:38912
    ds_read_b128 v[108:111], v6 offset:39936
    ds_read_b128 v[120:123], v6 offset:55296
    ds_read_b128 v[124:127], v6 offset:56320
    s_waitcnt lgkmcnt(0)
    v_mfma_f32_32x32x16_bf16 v[56:71], v[104:107], v[16:19], 0
    v_mfma_f32_32x32x16_bf16 v[56:71], v[108:111], v[20:23], v[56:71]
    s_nop 11
    v_max3_f32 v11, v56, v57, v58
    v_max3_f32 v11, v11, v59, v60
    v_max3_f32 v11, v11, v61, v62
    v_max3_f32 v11, v11, v63, v64
    v_max3_f32 v11, v11, v65, v66
    v_max3_f32 v11, v11, v67, v68
    v_max3_f32 v11, v11, v69, v70
    v_max_f32 v11, v11, v71
    v_mov_b32 v13, v11
    s_nop 1
    v_permlane32_swap_b32 v11, v13
    v_max_f32 v11, v11, v13
    v_max_f32 v11, v11, v12
    v_sub_f32 v10, v12, v11
    v_exp_f32 v10, v10
    v_mov_b32 v12, v11
    v_sub_f32 v56, v56, v11
    v_exp_f32 v56, v56
    v_sub_f32 v57, v57, v11
    v_exp_f32 v57, v57
    v_sub_f32 v58, v58, v11
    v_exp_f32 v58, v58
    v_sub_f32 v59, v59, v11
    v_exp_f32 v59, v59
    v_sub_f32 v60, v60, v11
    v_exp_f32 v60, v60
    v_sub_f32 v61, v61, v11
    v_exp_f32 v61, v61
    v_sub_f32 v62, v62, v11
    v_exp_f32 v62, v62
    v_sub_f32 v63, v63, v11
    v_exp_f32 v63, v63
    v_sub_f32 v64, v64, v11
    v_exp_f32 v64, v64
    v_sub_f32 v65, v65, v11
    v_exp_f32 v65, v65
    v_sub_f32 v66, v66, v11
    v_exp_f32 v66, v66
    v_sub_f32 v67, v67, v11
    v_exp_f32 v67, v67
    v_sub_f32 v68, v68, v11
    v_exp_f32 v68, v68
    v_sub_f32 v69, v69, v11
    v_exp_f32 v69, v69
    v_sub_f32 v70, v70, v11
    v_exp_f32 v70, v70
    v_sub_f32 v71, v71, v11
    v_exp_f32 v71, v71
    v_cvt_pk_bf16_f32 v72, v56, v57
    v_cvt_pk_bf16_f32 v73, v58, v59
    v_cvt_pk_bf16_f32 v74, v60, v61
    v_cvt_pk_bf16_f32 v75, v62, v63
    v_cvt_pk_bf16_f32 v76, v64, v65
    v_cvt_pk_bf16_f32 v77, v66, v67
    v_cvt_pk_bf16_f32 v78, v68, v69
    v_cvt_pk_bf16_f32 v79, v70, v71
    v_mul_f32 v80, v10, v80
    v_mul_f32 v81, v10, v81
    v_mul_f32 v82, v10, v82
    v_mul_f32 v83, v10, v83
    v_mul_f32 v84, v10, v84
    v_mul_f32 v85, v10, v85
    v_mul_f32 v86, v10, v86
    v_mul_f32 v87, v10, v87
    v_mul_f32 v88, v10, v88
    v_mul_f32 v89, v10, v89
    v_mul_f32 v90, v10, v90
    v_mul_f32 v91, v10, v91
    v_mul_f32 v92, v10, v92
    v_mul_f32 v93, v10, v93
    v_mul_f32 v94, v10, v94
    v_mul_f32 v95, v10, v95
    s_nop 1
    v_mfma_f32_32x32x16_bf16 v[80:95], v[120:123], v[72:75], v[80:95]
    v_mfma_f32_32x32x16_bf16 v[80:95], v[124:127], v[76:79], v[80:95]
    s_barrier
    s_mul_i32 s38, s23, 5120
    s_add_u32 s38, s38, 131072
    v_add_u32 v10, s38, v3
    s_cmp_eq_u32 s24, 0
    s_cbranch_scc1 K2_C1_S
    s_nop 5
    ds_write_b128 v10, v[80:83] offset:0
    ds_write_b128 v10, v[84:87] offset:1024
    ds_write_b128 v10, v[88:91] offset:2048
    ds_write_b128 v10, v[92:95] offset:3072
    ds_write_b32 v10, v12 offset:4096
K2_C1_S:
    s_waitcnt lgkmcnt(0)
    s_barrier
K2_MERGE:
    s_nop 15
    s_waitcnt vmcnt(0)
    s_cmp_eq_u32 s24, 0
    s_cbranch_scc0 K2_ABR
    ds_read_b128 v[40:43], v10 offset:0
    ds_read_b128 v[44:47], v10 offset:1024
    ds_read_b128 v[48:51], v10 offset:2048
    ds_read_b128 v[52:55], v10 offset:3072
    ds_read_b32 v11, v10 offset:4096
    s_waitcnt lgkmcnt(0)
    v_max_f32 v13, v11, v12
    v_sub_f32 v11, v11, v13
    v_sub_f32 v12, v12, v13
    v_exp_f32 v11, v11
    v_exp_f32 v12, v12
    s_nop 0
    v_mul_f32 v80, v12, v80
    v_fmac_f32 v80, v11, v40
    v_mul_f32 v81, v12, v81
    v_fmac_f32 v81, v11, v41
    v_mul_f32 v82, v12, v82
    v_fmac_f32 v82, v11, v42
    v_mul_f32 v83, v12, v83
    v_fmac_f32 v83, v11, v43
    v_mul_f32 v84, v12, v84
    v_fmac_f32 v84, v11, v44
    v_mul_f32 v85, v12, v85
    v_fmac_f32 v85, v11, v45
    v_mul_f32 v86, v12, v86
    v_fmac_f32 v86, v11, v46
    v_mul_f32 v87, v12, v87
    v_fmac_f32 v87, v11, v47
    v_mul_f32 v88, v12, v88
    v_fmac_f32 v88, v11, v48
    v_mul_f32 v89, v12, v89
    v_fmac_f32 v89, v11, v49
    v_mul_f32 v90, v12, v90
    v_fmac_f32 v90, v11, v50
    v_mul_f32 v91, v12, v91
    v_fmac_f32 v91, v11, v51
    v_mul_f32 v92, v12, v92
    v_fmac_f32 v92, v11, v52
    v_mul_f32 v93, v12, v93
    v_fmac_f32 v93, v11, v53
    v_mul_f32 v94, v12, v94
    v_fmac_f32 v94, v11, v54
    v_mul_f32 v95, v12, v95
    v_fmac_f32 v95, v11, v55
    v_mov_b32 v13, v92
    v_mov_b32 v14, v92
    s_nop 1
    v_permlane32_swap_b32 v13, v14
    v_rcp_f32 v14, v14
    s_nop 0
    v_mul_f32 v14, v14, v15
    v_mul_f32 v80, v14, v80
    v_mul_f32 v81, v14, v81
    v_mul_f32 v82, v14, v82
    v_mul_f32 v83, v14, v83
    v_mul_f32 v84, v14, v84
    v_mul_f32 v85, v14, v85
    v_mul_f32 v86, v14, v86
    v_mul_f32 v87, v14, v87
    v_mul_f32 v88, v14, v88
    v_mul_f32 v89, v14, v89
    v_mul_f32 v90, v14, v90
    v_mul_f32 v91, v14, v91
    v_mul_f32 v92, v14, v92
    v_mul_f32 v93, v14, v93
    v_mul_f32 v94, v14, v94
    v_mul_f32 v95, v14, v95
    v_cvt_pk_bf16_f32 v80, v80, v81
    v_cvt_pk_bf16_f32 v81, v82, v83
    v_cvt_pk_bf16_f32 v82, v84, v85
    v_cvt_pk_bf16_f32 v83, v86, v87
    v_cvt_pk_bf16_f32 v84, v88, v89
    v_cvt_pk_bf16_f32 v85, v90, v91
    v_cvt_pk_bf16_f32 v86, v92, v93
    v_cvt_pk_bf16_f32 v87, v94, v95
    v_cmp_gt_u32 vcc, 32, v2
    v_mov_b32 v13, 0
    s_nop 0
    v_cndmask_b32 v86, v13, v86, vcc
    v_cndmask_b32 v87, v13, v87, vcc
    s_lshl_b32 s38, s25, 16
    s_lshl_b32 s39, s20, 11
    s_add_u32 s38, s38, s39
    s_add_u32 s38, s38, 12615680
    buffer_store_dwordx4 v[80:83], v3, s[8:11], s38 offen sc1
    buffer_store_dwordx4 v[84:87], v3, s[8:11], s38 offen offset:1024 sc1
    s_waitcnt vmcnt(0)
    s_endpgm
K2_ABR:
    s_nop 3
    v_mfma_f32_32x32x16_bf16 v[40:55], v[136:139], v[128:131], 0
    v_mfma_f32_32x32x16_bf16 v[40:55], v[140:143], v[132:135], v[40:55]
    v_mfma_f32_32x32x16_bf16 v[56:71], v[144:147], v[128:131], 0
    v_mfma_f32_32x32x16_bf16 v[56:71], v[148:151], v[132:135], v[56:71]
    v_mov_b32 v12, 0xff800000
    s_cmp_eq_u32 s25, 0
    s_cselect_b32 s56, 0, -1
    s_mov_b32 s57, s56
    s_mov_b32 s48, 0x0
    s_mov_b32 s49, 0x5
    s_and_b64 s[48:49], s[48:49], s[56:57]
    s_nop 2
    v_cndmask_b32 v48, v12, v48, s[48:49]
    s_mov_b32 s50, 0x0
    s_mov_b32 s51, 0xa
    s_and_b64 s[50:51], s[50:51], s[56:57]
    v_cndmask_b32 v49, v12, v49, s[50:51]
    s_mov_b32 s52, 0x1
    s_mov_b32 s53, 0x15
    s_and_b64 s[52:53], s[52:53], s[56:57]
    v_cndmask_b32 v50, v12, v50, s[52:53]
    s_mov_b32 s54, 0x2
    s_mov_b32 s55, 0x2a
    s_and_b64 s[54:55], s[54:55], s[56:57]
    v_cndmask_b32 v51, v12, v51, s[54:55]
    s_mov_b32 s48, 0x55
    s_mov_b32 s49, 0x555
    s_and_b64 s[48:49], s[48:49], s[56:57]
    v_cndmask_b32 v52, v12, v52, s[48:49]
    s_mov_b32 s50, 0xaa
    s_mov_b32 s51, 0xaaa
    s_and_b64 s[50:51], s[50:51], s[56:57]
    v_cndmask_b32 v53, v12, v53, s[50:51]
    s_mov_b32 s52, 0x155
    s_mov_b32 s53, 0x1555
    s_and_b64 s[52:53], s[52:53], s[56:57]
    v_cndmask_b32 v54, v12, v54, s[52:53]
    s_mov_b32 s54, 0x2aa
    s_mov_b32 s55, 0x2aaa
    s_and_b64 s[54:55], s[54:55], s[56:57]
    v_cndmask_b32 v55, v12, v55, s[54:55]
    s_mov_b32 s48, 0x5555
    s_mov_b32 s49, 0x55550
    v_cndmask_b32 v56, v12, v56, s[48:49]
    s_mov_b32 s50, 0xaaaa
    s_mov_b32 s51, 0xaaaa0
    v_cndmask_b32 v57, v12, v57, s[50:51]
    s_mov_b32 s52, 0x15554
    s_mov_b32 s53, 0x155540
    v_cndmask_b32 v58, v12, v58, s[52:53]
    s_mov_b32 s54, 0x2aaa8
    s_mov_b32 s55, 0x2aaa80
    v_cndmask_b32 v59, v12, v59, s[54:55]
    s_mov_b32 s48, 0x555500
    s_mov_b32 s49, 0x5555000
    v_cndmask_b32 v60, v12, v60, s[48:49]
    s_mov_b32 s50, 0xaaaa00
    s_mov_b32 s51, 0xaaaa000
    v_cndmask_b32 v61, v12, v61, s[50:51]
    s_mov_b32 s52, 0x1555400
    s_mov_b32 s53, 0x15554000
    v_cndmask_b32 v62, v12, v62, s[52:53]
    s_mov_b32 s54, 0x2aaa800
    s_mov_b32 s55, 0x2aaa8000
    v_cndmask_b32 v63, v12, v63, s[54:55]
    s_mov_b32 s48, 0x55550000
    s_mov_b32 s49, 0x55500000
    v_cndmask_b32 v64, v12, v64, s[48:49]
    s_mov_b32 s50, 0xaaaa0000
    s_mov_b32 s51, 0xaaa00000
    v_cndmask_b32 v65, v12, v65, s[50:51]
    s_mov_b32 s52, 0x55540000
    s_mov_b32 s53, 0x55400000
    v_cndmask_b32 v66, v12, v66, s[52:53]
    s_mov_b32 s54, 0xaaa80000
    s_mov_b32 s55, 0xaa800000
    v_cndmask_b32 v67, v12, v67, s[54:55]
    s_mov_b32 s48, 0x55000000
    s_mov_b32 s49, 0x50000000
    v_cndmask_b32 v68, v12, v68, s[48:49]
    s_mov_b32 s50, 0xaa000000
    s_mov_b32 s51, 0xa0000000
    v_cndmask_b32 v69, v12, v69, s[50:51]
    s_mov_b32 s52, 0x54000000
    s_mov_b32 s53, 0x40000000
    v_cndmask_b32 v70, v12, v70, s[52:53]
    s_mov_b32 s54, 0xa8000000
    s_mov_b32 s55, 0x80000000
    v_cndmask_b32 v71, v12, v71, s[54:55]
    v_max3_f32 v13, v48, v49, v50
    v_max3_f32 v13, v13, v51, v52
    v_max3_f32 v13, v13, v53, v54
    v_max3_f32 v13, v13, v55, v56
    v_max3_f32 v13, v13, v57, v58
    v_max3_f32 v13, v13, v59, v60
    v_max3_f32 v13, v13, v61, v62
    v_max3_f32 v13, v13, v63, v64
    v_max3_f32 v13, v13, v65, v66
    v_max3_f32 v13, v13, v67, v68
    v_max3_f32 v13, v13, v69, v70
    v_max_f32 v13, v13, v71
    v_mov_b32 v14, v13
    s_nop 1
    v_permlane32_swap_b32 v13, v14
    v_max_f32 v13, v13, v14
    v_sub_f32 v48, v48, v13
    v_exp_f32 v48, v48
    v_sub_f32 v49, v49, v13
    v_exp_f32 v49, v49
    v_sub_f32 v50, v50, v13
    v_exp_f32 v50, v50
    v_sub_f32 v51, v51, v13
    v_exp_f32 v51, v51
    v_sub_f32 v52, v52, v13
    v_exp_f32 v52, v52
    v_sub_f32 v53, v53, v13
    v_exp_f32 v53, v53
    v_sub_f32 v54, v54, v13
    v_exp_f32 v54, v54
    v_sub_f32 v55, v55, v13
    v_exp_f32 v55, v55
    v_sub_f32 v56, v56, v13
    v_exp_f32 v56, v56
    v_sub_f32 v57, v57, v13
    v_exp_f32 v57, v57
    v_sub_f32 v58, v58, v13
    v_exp_f32 v58, v58
    v_sub_f32 v59, v59, v13
    v_exp_f32 v59, v59
    v_sub_f32 v60, v60, v13
    v_exp_f32 v60, v60
    v_sub_f32 v61, v61, v13
    v_exp_f32 v61, v61
    v_sub_f32 v62, v62, v13
    v_exp_f32 v62, v62
    v_sub_f32 v63, v63, v13
    v_exp_f32 v63, v63
    v_sub_f32 v64, v64, v13
    v_exp_f32 v64, v64
    v_sub_f32 v65, v65, v13
    v_exp_f32 v65, v65
    v_sub_f32 v66, v66, v13
    v_exp_f32 v66, v66
    v_sub_f32 v67, v67, v13
    v_exp_f32 v67, v67
    v_sub_f32 v68, v68, v13
    v_exp_f32 v68, v68
    v_sub_f32 v69, v69, v13
    v_exp_f32 v69, v69
    v_sub_f32 v70, v70, v13
    v_exp_f32 v70, v70
    v_sub_f32 v71, v71, v13
    v_exp_f32 v71, v71
    v_cvt_pk_bf16_f32 v40, v48, v49
    v_cvt_pk_bf16_f32 v41, v50, v51
    v_cvt_pk_bf16_f32 v42, v52, v53
    v_cvt_pk_bf16_f32 v43, v54, v55
    v_cvt_pk_bf16_f32 v44, v56, v57
    v_cvt_pk_bf16_f32 v45, v58, v59
    v_cvt_pk_bf16_f32 v46, v60, v61
    v_cvt_pk_bf16_f32 v47, v62, v63
    v_cvt_pk_bf16_f32 v48, v64, v65
    v_cvt_pk_bf16_f32 v49, v66, v67
    v_cvt_pk_bf16_f32 v50, v68, v69
    v_cvt_pk_bf16_f32 v51, v70, v71
    v_mfma_f32_32x32x16_bf16 v[80:95], v[156:159], v[40:43], 0
    v_mfma_f32_32x32x16_bf16 v[80:95], v[160:163], v[44:47], v[80:95]
    v_mfma_f32_32x32x16_bf16 v[80:95], v[164:167], v[48:51], v[80:95]
    s_nop 11
    v_mov_b32 v13, v92
    v_mov_b32 v14, v92
    s_nop 1
    v_permlane32_swap_b32 v13, v14
    v_rcp_f32 v14, v14
    s_nop 0
    v_mul_f32 v14, v14, v9
    v_mul_f32 v80, v14, v80
    v_mul_f32 v81, v14, v81
    v_mul_f32 v82, v14, v82
    v_mul_f32 v83, v14, v83
    v_mul_f32 v84, v14, v84
    v_mul_f32 v85, v14, v85
    v_mul_f32 v86, v14, v86
    v_mul_f32 v87, v14, v87
    v_mul_f32 v88, v14, v88
    v_mul_f32 v89, v14, v89
    v_mul_f32 v90, v14, v90
    v_mul_f32 v91, v14, v91
    v_mul_f32 v92, v14, v92
    v_mul_f32 v93, v14, v93
    v_mul_f32 v94, v14, v94
    v_mul_f32 v95, v14, v95
    v_cvt_pk_bf16_f32 v80, v80, v81
    v_cvt_pk_bf16_f32 v81, v82, v83
    v_cvt_pk_bf16_f32 v82, v84, v85
    v_cvt_pk_bf16_f32 v83, v86, v87
    v_cvt_pk_bf16_f32 v84, v88, v89
    v_cvt_pk_bf16_f32 v85, v90, v91
    v_cvt_pk_bf16_f32 v86, v92, v93
    v_cvt_pk_bf16_f32 v87, v94, v95
    v_cmp_gt_u32 vcc, 32, v2
    v_mov_b32 v13, 0
    s_nop 0
    v_cndmask_b32 v86, v13, v86, vcc
    v_cndmask_b32 v87, v13, v87, vcc
    s_lshl_b32 s38, s25, 16
    s_lshl_b32 s39, s20, 11
    s_add_u32 s38, s38, s39
    s_add_u32 s38, s38, 12582912
    buffer_store_dwordx4 v[80:83], v3, s[8:11], s38 offen sc1
    buffer_store_dwordx4 v[84:87], v3, s[8:11], s38 offen offset:1024 sc1
K2_END:
    s_endpgm
.p2align 8
.globl out_kernel
.type out_kernel,@function
out_kernel:
    s_cmp_ge_u32 s2, 224
    s_cbranch_scc1 K3_END
    s_load_dwordx2 s[4:5], s[0:1], 72
    s_load_dwordx2 s[6:7], s[0:1], 56
    s_and_b32 s20, s2, 7
    s_lshr_b32 s21, s2, 3
    s_mul_i32 s22, s21, 37
    s_lshr_b32 s22, s22, 8
    s_mul_i32 s23, s22, 7
    s_sub_u32 s23, s21, s23
    s_lshl_b32 s20, s20, 2
    s_add_u32 s22, s22, s20
    v_lshrrev_b32 v1, 6, v0
    v_and_b32 v2, 63, v0
    v_readfirstlane_b32 s32, v1
    s_and_b32 s24, s32, 3
    s_and_b32 s25, s24, 1
    s_lshr_b32 s26, s24, 1
    v_lshlrev_b32 v3, 4, v2
    s_cmp_lt_u32 s32, 4
    s_cbranch_scc1 K3_COMPUTE
    s_lshl_b32 s27, s22, 1
    s_add_u32 s27, s27, s24
    s_lshl_b32 s27, s27, 16
    s_add_u32 s27, s27, 12582912
    s_lshl_b32 s28, s23, 1
    s_add_u32 s28, s28, s24
    s_sub_u32 s28, s28, 2
    s_lshl_b32 s28, s28, 16
    s_add_u32 s28, s28, 16777216
    s_cmp_lt_u32 s24, 2
    s_cselect_b32 s27, s27, s28
    s_lshl_b32 s29, s24, 13
    s_waitcnt lgkmcnt(0)
    s_mov_b32 s8, s4
    s_and_b32 s9, s5, 0xffff
    s_mov_b32 s10, 18874368
    s_mov_b32 s11, 0x20000
    s_add_u32 s30, s29, 0
    s_mov_b32 m0, s30
    s_add_u32 s31, s27, 0
    buffer_load_dwordx4 v3, s[8:11], s31 offen offset:0 lds
    buffer_load_dwordx4 v3, s[8:11], s31 offen offset:1024 lds
    buffer_load_dwordx4 v3, s[8:11], s31 offen offset:2048 lds
    buffer_load_dwordx4 v3, s[8:11], s31 offen offset:3072 lds
    s_add_u32 s30, s29, 4096
    s_mov_b32 m0, s30
    s_add_u32 s31, s27, 4096
    buffer_load_dwordx4 v3, s[8:11], s31 offen offset:0 lds
    buffer_load_dwordx4 v3, s[8:11], s31 offen offset:1024 lds
    buffer_load_dwordx4 v3, s[8:11], s31 offen offset:2048 lds
    buffer_load_dwordx4 v3, s[8:11], s31 offen offset:3072 lds
    s_add_u32 s30, s29, 32768
    s_mov_b32 m0, s30
    s_add_u32 s31, s27, 8192
    buffer_load_dwordx4 v3, s[8:11], s31 offen offset:0 lds
    buffer_load_dwordx4 v3, s[8:11], s31 offen offset:1024 lds
    buffer_load_dwordx4 v3, s[8:11], s31 offen offset:2048 lds
    buffer_load_dwordx4 v3, s[8:11], s31 offen offset:3072 lds
    s_add_u32 s30, s29, 36864
    s_mov_b32 m0, s30
    s_add_u32 s31, s27, 12288
    buffer_load_dwordx4 v3, s[8:11], s31 offen offset:0 lds
    buffer_load_dwordx4 v3, s[8:11], s31 offen offset:1024 lds
    buffer_load_dwordx4 v3, s[8:11], s31 offen offset:2048 lds
    buffer_load_dwordx4 v3, s[8:11], s31 offen offset:3072 lds
    s_waitcnt vmcnt(8)
    s_barrier
    s_add_u32 s30, s29, 65536
    s_mov_b32 m0, s30
    s_add_u32 s31, s27, 16384
    buffer_load_dwordx4 v3, s[8:11], s31 offen offset:0 lds
    buffer_load_dwordx4 v3, s[8:11], s31 offen offset:1024 lds
    buffer_load_dwordx4 v3, s[8:11], s31 offen offset:2048 lds
    buffer_load_dwordx4 v3, s[8:11], s31 offen offset:3072 lds
    s_add_u32 s30, s29, 69632
    s_mov_b32 m0, s30
    s_add_u32 s31, s27, 20480
    buffer_load_dwordx4 v3, s[8:11], s31 offen offset:0 lds
    buffer_load_dwordx4 v3, s[8:11], s31 offen offset:1024 lds
    buffer_load_dwordx4 v3, s[8:11], s31 offen offset:2048 lds
    buffer_load_dwordx4 v3, s[8:11], s31 offen offset:3072 lds
    s_add_u32 s30, s29, 98304
    s_mov_b32 m0, s30
    s_add_u32 s31, s27, 24576
    buffer_load_dwordx4 v3, s[8:11], s31 offen offset:0 lds
    buffer_load_dwordx4 v3, s[8:11], s31 offen offset:1024 lds
    buffer_load_dwordx4 v3, s[8:11], s31 offen offset:2048 lds
    buffer_load_dwordx4 v3, s[8:11], s31 offen offset:3072 lds
    s_add_u32 s30, s29, 102400
    s_mov_b32 m0, s30
    s_add_u32 s31, s27, 28672
    buffer_load_dwordx4 v3, s[8:11], s31 offen offset:0 lds
    buffer_load_dwordx4 v3, s[8:11], s31 offen offset:1024 lds
    buffer_load_dwordx4 v3, s[8:11], s31 offen offset:2048 lds
    buffer_load_dwordx4 v3, s[8:11], s31 offen offset:3072 lds
    s_waitcnt vmcnt(16)
    s_barrier
    s_add_u32 s30, s29, 131072
    s_mov_b32 m0, s30
    s_add_u32 s31, s27, 32768
    buffer_load_dwordx4 v3, s[8:11], s31 offen offset:0 lds
    buffer_load_dwordx4 v3, s[8:11], s31 offen offset:1024 lds
    buffer_load_dwordx4 v3, s[8:11], s31 offen offset:2048 lds
    buffer_load_dwordx4 v3, s[8:11], s31 offen offset:3072 lds
    s_add_u32 s30, s29, 135168
    s_mov_b32 m0, s30
    s_add_u32 s31, s27, 36864
    buffer_load_dwordx4 v3, s[8:11], s31 offen offset:0 lds
    buffer_load_dwordx4 v3, s[8:11], s31 offen offset:1024 lds
    buffer_load_dwordx4 v3, s[8:11], s31 offen offset:2048 lds
    buffer_load_dwordx4 v3, s[8:11], s31 offen offset:3072 lds
    s_waitcnt vmcnt(16)
    s_barrier
    s_add_u32 s30, s29, 0
    s_mov_b32 m0, s30
    s_add_u32 s31, s27, 40960
    buffer_load_dwordx4 v3, s[8:11], s31 offen offset:0 lds
    buffer_load_dwordx4 v3, s[8:11], s31 offen offset:1024 lds
    buffer_load_dwordx4 v3, s[8:11], s31 offen offset:2048 lds
    buffer_load_dwordx4 v3, s[8:11], s31 offen offset:3072 lds
    s_add_u32 s30, s29, 4096
    s_mov_b32 m0, s30
    s_add_u32 s31, s27, 45056
    buffer_load_dwordx4 v3, s[8:11], s31 offen offset:0 lds
    buffer_load_dwordx4 v3, s[8:11], s31 offen offset:1024 lds
    buffer_load_dwordx4 v3, s[8:11], s31 offen offset:2048 lds
    buffer_load_dwordx4 v3, s[8:11], s31 offen offset:3072 lds
    s_waitcnt vmcnt(16)
    s_barrier
    s_add_u32 s30, s29, 32768
    s_mov_b32 m0, s30
    s_add_u32 s31, s27, 49152
    buffer_load_dwordx4 v3, s[8:11], s31 offen offset:0 lds
    buffer_load_dwordx4 v3, s[8:11], s31 offen offset:1024 lds
    buffer_load_dwordx4 v3, s[8:11], s31 offen offset:2048 lds
    buffer_load_dwordx4 v3, s[8:11], s31 offen offset:3072 lds
    s_add_u32 s30, s29, 36864
    s_mov_b32 m0, s30
    s_add_u32 s31, s27, 53248
    buffer_load_dwordx4 v3, s[8:11], s31 offen offset:0 lds
    buffer_load_dwordx4 v3, s[8:11], s31 offen offset:1024 lds
    buffer_load_dwordx4 v3, s[8:11], s31 offen offset:2048 lds
    buffer_load_dwordx4 v3, s[8:11], s31 offen offset:3072 lds
    s_waitcnt vmcnt(16)
    s_barrier
    s_add_u32 s30, s29, 65536
    s_mov_b32 m0, s30
    s_add_u32 s31, s27, 57344
    buffer_load_dwordx4 v3, s[8:11], s31 offen offset:0 lds
    buffer_load_dwordx4 v3, s[8:11], s31 offen offset:1024 lds
    buffer_load_dwordx4 v3, s[8:11], s31 offen offset:2048 lds
    buffer_load_dwordx4 v3, s[8:11], s31 offen offset:3072 lds
    s_add_u32 s30, s29, 69632
    s_mov_b32 m0, s30
    s_add_u32 s31, s27, 61440
    buffer_load_dwordx4 v3, s[8:11], s31 offen offset:0 lds
    buffer_load_dwordx4 v3, s[8:11], s31 offen offset:1024 lds
    buffer_load_dwordx4 v3, s[8:11], s31 offen offset:2048 lds
    buffer_load_dwordx4 v3, s[8:11], s31 offen offset:3072 lds
    s_waitcnt vmcnt(16)
    s_barrier
    s_waitcnt vmcnt(8)
    s_barrier
    s_waitcnt vmcnt(0)
    s_barrier
    s_endpgm
K3_COMPUTE:
    s_lshl_b32 s30, s25, 13
    v_add_u32 v4, s30, v3
    s_lshl_b32 s30, s26, 13
    s_add_u32 s30, s30, 16384
    v_add_u32 v5, s30, v3
    v_add_u32 v6, 0x10000, v4
    v_add_u32 v7, 0x10000, v5
    v_and_b32 v8, 31, v2
    s_lshl_b32 s30, s22, 6
    s_lshl_b32 s31, s25, 5
    s_add_u32 s30, s30, s31
    v_add_u32 v8, s30, v8
    s_movk_i32 s31, 896
    v_mul_lo_u32 v8, v8, s31
    v_lshrrev_b32 v9, 5, v2
    v_lshl_add_u32 v8, v9, 4, v8
    s_lshl_b32 s30, s23, 7
    s_lshl_b32 s31, s26, 6
    s_add_u32 s30, s30, s31
    s_waitcnt lgkmcnt(0)
    s_mov_b32 s12, s6
    s_and_b32 s13, s7, 0xffff
    s_mov_b32 s14, 1835008
    s_mov_b32 s15, 0x20000
    v_add_u32 v10, 0x20000, v4
    v_add_u32 v11, 0x20000, v5
    s_barrier
    ds_read_b128 v[32:35], v5 offset:0
    ds_read_b128 v[48:51], v4 offset:0
    ds_read_b128 v[36:39], v5 offset:1024
    ds_read_b128 v[52:55], v4 offset:1024
    ds_read_b128 v[40:43], v5 offset:2048
    ds_read_b128 v[56:59], v4 offset:2048
    ds_read_b128 v[44:47], v5 offset:3072
    ds_read_b128 v[60:63], v4 offset:3072
    s_waitcnt lgkmcnt(6)
    v_mfma_f32_32x32x16_bf16 v[16:31], v[32:35], v[48:51], 0
    ds_read_b128 v[32:35], v5 offset:4096
    ds_read_b128 v[48:51], v4 offset:4096
    s_waitcnt lgkmcnt(6)
    v_mfma_f32_32x32x16_bf16 v[16:31], v[36:39], v[52:55], v[16:31]
    ds_read_b128 v[36:39], v5 offset:5120
    ds_read_b128 v[52:55], v4 offset:5120
    s_waitcnt lgkmcnt(6)
    v_mfma_f32_32x32x16_bf16 v[16:31], v[40:43], v[56:59], v[16:31]
    ds_read_b128 v[40:43], v5 offset:6144
    ds_read_b128 v[56:59], v4 offset:6144
    s_waitcnt lgkmcnt(6)
    v_mfma_f32_32x32x16_bf16 v[16:31], v[44:47], v[60:63], v[16:31]
    ds_read_b128 v[44:47], v5 offset:7168
    ds_read_b128 v[60:63], v4 offset:7168
    s_waitcnt lgkmcnt(6)
    v_mfma_f32_32x32x16_bf16 v[16:31], v[32:35], v[48:51], v[16:31]
    s_barrier
    ds_read_b128 v[32:35], v5 offset:32768
    ds_read_b128 v[48:51], v4 offset:32768
    s_waitcnt lgkmcnt(6)
    v_mfma_f32_32x32x16_bf16 v[16:31], v[36:39], v[52:55], v[16:31]
    ds_read_b128 v[36:39], v5 offset:33792
    ds_read_b128 v[52:55], v4 offset:33792
    s_waitcnt lgkmcnt(6)
    v_mfma_f32_32x32x16_bf16 v[16:31], v[40:43], v[56:59], v[16:31]
    ds_read_b128 v[40:43], v5 offset:34816
    ds_read_b128 v[56:59], v4 offset:34816
    s_waitcnt lgkmcnt(6)
    v_mfma_f32_32x32x16_bf16 v[16:31], v[44:47], v[60:63], v[16:31]
    ds_read_b128 v[44:47], v5 offset:35840
    ds_read_b128 v[60:63], v4 offset:35840
    s_waitcnt lgkmcnt(6)
    v_mfma_f32_32x32x16_bf16 v[16:31], v[32:35], v[48:51], v[16:31]
    ds_read_b128 v[32:35], v5 offset:36864
    ds_read_b128 v[48:51], v4 offset:36864
    s_waitcnt lgkmcnt(6)
    v_mfma_f32_32x32x16_bf16 v[16:31], v[36:39], v[52:55], v[16:31]
    ds_read_b128 v[36:39], v5 offset:37888
    ds_read_b128 v[52:55], v4 offset:37888
    s_waitcnt lgkmcnt(6)
    v_mfma_f32_32x32x16_bf16 v[16:31], v[40:43], v[56:59], v[16:31]
    ds_read_b128 v[40:43], v5 offset:38912
    ds_read_b128 v[56:59], v4 offset:38912
    s_waitcnt lgkmcnt(6)
    v_mfma_f32_32x32x16_bf16 v[16:31], v[44:47], v[60:63], v[16:31]
    ds_read_b128 v[44:47], v5 offset:39936
    ds_read_b128 v[60:63], v4 offset:39936
    s_waitcnt lgkmcnt(6)
    v_mfma_f32_32x32x16_bf16 v[16:31], v[32:35], v[48:51], v[16:31]
    s_barrier
    ds_read_b128 v[32:35], v7 offset:0
    ds_read_b128 v[48:51], v6 offset:0
    s_waitcnt lgkmcnt(6)
    v_mfma_f32_32x32x16_bf16 v[16:31], v[36:39], v[52:55], v[16:31]
    ds_read_b128 v[36:39], v7 offset:1024
    ds_read_b128 v[52:55], v6 offset:1024
    s_waitcnt lgkmcnt(6)
    v_mfma_f32_32x32x16_bf16 v[16:31], v[40:43], v[56:59], v[16:31]
    ds_read_b128 v[40:43], v7 offset:2048
    ds_read_b128 v[56:59], v6 offset:2048
    s_waitcnt lgkmcnt(6)
    v_mfma_f32_32x32x16_bf16 v[16:31], v[44:47], v[60:63], v[16:31]
    ds_read_b128 v[44:47], v7 offset:3072
    ds_read_b128 v[60:63], v6 offset:3072
    s_waitcnt lgkmcnt(6)
    v_mfma_f32_32x32x16_bf16 v[16:31], v[32:35], v[48:51], v[16:31]
    ds_read_b128 v[32:35], v7 offset:4096
    ds_read_b128 v[48:51], v6 offset:4096
    s_waitcnt lgkmcnt(6)
    v_mfma_f32_32x32x16_bf16 v[16:31], v[36:39], v[52:55], v[16:31]
    ds_read_b128 v[36:39], v7 offset:5120
    ds_read_b128 v[52:55], v6 offset:5120
    s_waitcnt lgkmcnt(6)
    v_mfma_f32_32x32x16_bf16 v[16:31], v[40:43], v[56:59], v[16:31]
    ds_read_b128 v[40:43], v7 offset:6144
    ds_read_b128 v[56:59], v6 offset:6144
    s_waitcnt lgkmcnt(6)
    v_mfma_f32_32x32x16_bf16 v[16:31], v[44:47], v[60:63], v[16:31]
    ds_read_b128 v[44:47], v7 offset:7168
    ds_read_b128 v[60:63], v6 offset:7168
    s_waitcnt lgkmcnt(6)
    v_mfma_f32_32x32x16_bf16 v[16:31], v[32:35], v[48:51], v[16:31]
    s_barrier
    ds_read_b128 v[32:35], v7 offset:32768
    ds_read_b128 v[48:51], v6 offset:32768
    s_waitcnt lgkmcnt(6)
    v_mfma_f32_32x32x16_bf16 v[16:31], v[36:39], v[52:55], v[16:31]
    ds_read_b128 v[36:39], v7 offset:33792
    ds_read_b128 v[52:55], v6 offset:33792
    s_waitcnt lgkmcnt(6)
    v_mfma_f32_32x32x16_bf16 v[16:31], v[40:43], v[56:59], v[16:31]
    ds_read_b128 v[40:43], v7 offset:34816
    ds_read_b128 v[56:59], v6 offset:34816
    s_waitcnt lgkmcnt(6)
    v_mfma_f32_32x32x16_bf16 v[16:31], v[44:47], v[60:63], v[16:31]
    ds_read_b128 v[44:47], v7 offset:35840
    ds_read_b128 v[60:63], v6 offset:35840
    s_waitcnt lgkmcnt(6)
    v_mfma_f32_32x32x16_bf16 v[16:31], v[32:35], v[48:51], v[16:31]
    ds_read_b128 v[32:35], v7 offset:36864
    ds_read_b128 v[48:51], v6 offset:36864
    s_waitcnt lgkmcnt(6)
    v_mfma_f32_32x32x16_bf16 v[16:31], v[36:39], v[52:55], v[16:31]
    ds_read_b128 v[36:39], v7 offset:37888
    ds_read_b128 v[52:55], v6 offset:37888
    s_waitcnt lgkmcnt(6)
    v_mfma_f32_32x32x16_bf16 v[16:31], v[40:43], v[56:59], v[16:31]
    ds_read_b128 v[40:43], v7 offset:38912
    ds_read_b128 v[56:59], v6 offset:38912
    s_waitcnt lgkmcnt(6)
    v_mfma_f32_32x32x16_bf16 v[16:31], v[44:47], v[60:63], v[16:31]
    ds_read_b128 v[44:47], v7 offset:39936
    ds_read_b128 v[60:63], v6 offset:39936
    s_waitcnt lgkmcnt(6)
    v_mfma_f32_32x32x16_bf16 v[16:31], v[32:35], v[48:51], v[16:31]
    s_barrier
    ds_read_b128 v[32:35], v11 offset:0
    ds_read_b128 v[48:51], v10 offset:0
    s_waitcnt lgkmcnt(6)
    v_mfma_f32_32x32x16_bf16 v[16:31], v[36:39], v[52:55], v[16:31]
    ds_read_b128 v[36:39], v11 offset:1024
    ds_read_b128 v[52:55], v10 offset:1024
    s_waitcnt lgkmcnt(6)
    v_mfma_f32_32x32x16_bf16 v[16:31], v[40:43], v[56:59], v[16:31]
    ds_read_b128 v[40:43], v11 offset:2048
    ds_read_b128 v[56:59], v10 offset:2048
    s_waitcnt lgkmcnt(6)
    v_mfma_f32_32x32x16_bf16 v[16:31], v[44:47], v[60:63], v[16:31]
    ds_read_b128 v[44:47], v11 offset:3072
    ds_read_b128 v[60:63], v10 offset:3072
    s_waitcnt lgkmcnt(6)
    v_mfma_f32_32x32x16_bf16 v[16:31], v[32:35], v[48:51], v[16:31]
    ds_read_b128 v[32:35], v11 offset:4096
    ds_read_b128 v[48:51], v10 offset:4096
    s_waitcnt lgkmcnt(6)
    v_mfma_f32_32x32x16_bf16 v[16:31], v[36:39], v[52:55], v[16:31]
    ds_read_b128 v[36:39], v11 offset:5120
    ds_read_b128 v[52:55], v10 offset:5120
    s_waitcnt lgkmcnt(6)
    v_mfma_f32_32x32x16_bf16 v[16:31], v[40:43], v[56:59], v[16:31]
    ds_read_b128 v[40:43], v11 offset:6144
    ds_read_b128 v[56:59], v10 offset:6144
    s_waitcnt lgkmcnt(6)
    v_mfma_f32_32x32x16_bf16 v[16:31], v[44:47], v[60:63], v[16:31]
    ds_read_b128 v[44:47], v11 offset:7168
    ds_read_b128 v[60:63], v10 offset:7168
    s_waitcnt lgkmcnt(6)
    v_mfma_f32_32x32x16_bf16 v[16:31], v[32:35], v[48:51], v[16:31]
    s_barrier
    ds_read_b128 v[32:35], v5 offset:0
    ds_read_b128 v[48:51], v4 offset:0
    s_waitcnt lgkmcnt(6)
    v_mfma_f32_32x32x16_bf16 v[16:31], v[36:39], v[52:55], v[16:31]
    ds_read_b128 v[36:39], v5 offset:1024
    ds_read_b128 v[52:55], v4 offset:1024
    s_waitcnt lgkmcnt(6)
    v_mfma_f32_32x32x16_bf16 v[16:31], v[40:43], v[56:59], v[16:31]
    ds_read_b128 v[40:43], v5 offset:2048
    ds_read_b128 v[56:59], v4 offset:2048
    s_waitcnt lgkmcnt(6)
    v_mfma_f32_32x32x16_bf16 v[16:31], v[44:47], v[60:63], v[16:31]
    ds_read_b128 v[44:47], v5 offset:3072
    ds_read_b128 v[60:63], v4 offset:3072
    s_waitcnt lgkmcnt(6)
    v_mfma_f32_32x32x16_bf16 v[16:31], v[32:35], v[48:51], v[16:31]
    ds_read_b128 v[32:35], v5 offset:4096
    ds_read_b128 v[48:51], v4 offset:4096
    s_waitcnt lgkmcnt(6)
    v_mfma_f32_32x32x16_bf16 v[16:31], v[36:39], v[52:55], v[16:31]
    ds_read_b128 v[36:39], v5 offset:5120
    ds_read_b128 v[52:55], v4 offset:5120
    s_waitcnt lgkmcnt(6)
    v_mfma_f32_32x32x16_bf16 v[16:31], v[40:43], v[56:59], v[16:31]
    ds_read_b128 v[40:43], v5 offset:6144
    ds_read_b128 v[56:59], v4 offset:6144
    s_waitcnt lgkmcnt(6)
    v_mfma_f32_32x32x16_bf16 v[16:31], v[44:47], v[60:63], v[16:31]
    ds_read_b128 v[44:47], v5 offset:7168
    ds_read_b128 v[60:63], v4 offset:7168
    s_waitcnt lgkmcnt(6)
    v_mfma_f32_32x32x16_bf16 v[16:31], v[32:35], v[48:51], v[16:31]
    s_barrier
    ds_read_b128 v[32:35], v5 offset:32768
    ds_read_b128 v[48:51], v4 offset:32768
    s_waitcnt lgkmcnt(6)
    v_mfma_f32_32x32x16_bf16 v[16:31], v[36:39], v[52:55], v[16:31]
    ds_read_b128 v[36:39], v5 offset:33792
    ds_read_b128 v[52:55], v4 offset:33792
    s_waitcnt lgkmcnt(6)
    v_mfma_f32_32x32x16_bf16 v[16:31], v[40:43], v[56:59], v[16:31]
    ds_read_b128 v[40:43], v5 offset:34816
    ds_read_b128 v[56:59], v4 offset:34816
    s_waitcnt lgkmcnt(6)
    v_mfma_f32_32x32x16_bf16 v[16:31], v[44:47], v[60:63], v[16:31]
    ds_read_b128 v[44:47], v5 offset:35840
    ds_read_b128 v[60:63], v4 offset:35840
    s_waitcnt lgkmcnt(6)
    v_mfma_f32_32x32x16_bf16 v[16:31], v[32:35], v[48:51], v[16:31]
    ds_read_b128 v[32:35], v5 offset:36864
    ds_read_b128 v[48:51], v4 offset:36864
    s_waitcnt lgkmcnt(6)
    v_mfma_f32_32x32x16_bf16 v[16:31], v[36:39], v[52:55], v[16:31]
    ds_read_b128 v[36:39], v5 offset:37888
    ds_read_b128 v[52:55], v4 offset:37888
    s_waitcnt lgkmcnt(6)
    v_mfma_f32_32x32x16_bf16 v[16:31], v[40:43], v[56:59], v[16:31]
    ds_read_b128 v[40:43], v5 offset:38912
    ds_read_b128 v[56:59], v4 offset:38912
    s_waitcnt lgkmcnt(6)
    v_mfma_f32_32x32x16_bf16 v[16:31], v[44:47], v[60:63], v[16:31]
    ds_read_b128 v[44:47], v5 offset:39936
    ds_read_b128 v[60:63], v4 offset:39936
    s_waitcnt lgkmcnt(6)
    v_mfma_f32_32x32x16_bf16 v[16:31], v[32:35], v[48:51], v[16:31]
    s_barrier
    ds_read_b128 v[32:35], v7 offset:0
    ds_read_b128 v[48:51], v6 offset:0
    s_waitcnt lgkmcnt(6)
    v_mfma_f32_32x32x16_bf16 v[16:31], v[36:39], v[52:55], v[16:31]
    ds_read_b128 v[36:39], v7 offset:1024
    ds_read_b128 v[52:55], v6 offset:1024
    s_waitcnt lgkmcnt(6)
    v_mfma_f32_32x32x16_bf16 v[16:31], v[40:43], v[56:59], v[16:31]
    ds_read_b128 v[40:43], v7 offset:2048
    ds_read_b128 v[56:59], v6 offset:2048
    s_waitcnt lgkmcnt(6)
    v_mfma_f32_32x32x16_bf16 v[16:31], v[44:47], v[60:63], v[16:31]
    ds_read_b128 v[44:47], v7 offset:3072
    ds_read_b128 v[60:63], v6 offset:3072
    s_waitcnt lgkmcnt(6)
    v_mfma_f32_32x32x16_bf16 v[16:31], v[32:35], v[48:51], v[16:31]
    ds_read_b128 v[32:35], v7 offset:4096
    ds_read_b128 v[48:51], v6 offset:4096
    s_waitcnt lgkmcnt(6)
    v_mfma_f32_32x32x16_bf16 v[16:31], v[36:39], v[52:55], v[16:31]
    ds_read_b128 v[36:39], v7 offset:5120
    ds_read_b128 v[52:55], v6 offset:5120
    s_waitcnt lgkmcnt(6)
    v_mfma_f32_32x32x16_bf16 v[16:31], v[40:43], v[56:59], v[16:31]
    ds_read_b128 v[40:43], v7 offset:6144
    ds_read_b128 v[56:59], v6 offset:6144
    s_waitcnt lgkmcnt(6)
    v_mfma_f32_32x32x16_bf16 v[16:31], v[44:47], v[60:63], v[16:31]
    ds_read_b128 v[44:47], v7 offset:7168
    ds_read_b128 v[60:63], v6 offset:7168
    s_waitcnt lgkmcnt(6)
    v_mfma_f32_32x32x16_bf16 v[16:31], v[32:35], v[48:51], v[16:31]
    s_waitcnt lgkmcnt(4)
    v_mfma_f32_32x32x16_bf16 v[16:31], v[36:39], v[52:55], v[16:31]
    s_waitcnt lgkmcnt(2)
    v_mfma_f32_32x32x16_bf16 v[16:31], v[40:43], v[56:59], v[16:31]
    s_waitcnt lgkmcnt(0)
    v_mfma_f32_32x32x16_bf16 v[16:31], v[44:47], v[60:63], v[16:31]
    s_nop 11
    v_cvt_pk_bf16_f32 v16, v16, v17
    v_cvt_pk_bf16_f32 v17, v18, v19
    v_cvt_pk_bf16_f32 v18, v20, v21
    v_cvt_pk_bf16_f32 v19, v22, v23
    v_cvt_pk_bf16_f32 v20, v24, v25
    v_cvt_pk_bf16_f32 v21, v26, v27
    v_cvt_pk_bf16_f32 v22, v28, v29
    v_cvt_pk_bf16_f32 v23, v30, v31
    v_permlane32_swap_b32 v16, v18
    v_permlane32_swap_b32 v17, v19
    v_permlane32_swap_b32 v20, v22
    v_permlane32_swap_b32 v21, v23
    buffer_store_dwordx4 v[16:19], v8, s[12:15], s30 offen offset:0
    buffer_store_dwordx4 v[20:23], v8, s[12:15], s30 offen offset:32
K3_END:
    s_endpgm
.section .rodata,"a"
.p2align 6
.amdhsa_kernel qkv_kernel
  .amdhsa_next_free_vgpr 160
  .amdhsa_next_free_sgpr 96
  .amdhsa_accum_offset 160
  .amdhsa_group_segment_fixed_size 0
  .amdhsa_kernarg_size 80
  .amdhsa_user_sgpr_count 2
  .amdhsa_user_sgpr_kernarg_segment_ptr 1
  .amdhsa_system_sgpr_workgroup_id_x 1
.end_amdhsa_kernel
.p2align 6
.amdhsa_kernel attn_kernel
  .amdhsa_next_free_vgpr 168
  .amdhsa_next_free_sgpr 96
  .amdhsa_accum_offset 168
  .amdhsa_group_segment_fixed_size 0
  .amdhsa_kernarg_size 80
  .amdhsa_user_sgpr_count 2
  .amdhsa_user_sgpr_kernarg_segment_ptr 1
  .amdhsa_system_sgpr_workgroup_id_x 1
.end_amdhsa_kernel
.p2align 6
.amdhsa_kernel out_kernel
  .amdhsa_next_free_vgpr 64
  .amdhsa_next_free_sgpr 96
  .amdhsa_accum_offset 64
  .amdhsa_group_segment_fixed_size 0
  .amdhsa_kernarg_size 80
  .amdhsa_user_sgpr_count 2
  .amdhsa_user_sgpr_kernarg_segment_ptr 1
  .amdhsa_system_sgpr_workgroup_id_x 1
.end_amdhsa_kernel
```
